```python
import torch

def _softmax(x, axis=-1):
    return torch.softmax(x, dim=axis)
def _gelu(x):
    return torch.nn.functional.gelu(x, approximate="tanh")
def _silu(x):
    return torch.nn.functional.silu(x)
def _sigmoid(x):
    return torch.sigmoid(x)
def _layernorm(x, axis=-1, eps=1e-5):
    m = x.mean(dim=axis, keepdim=True)
    v = x.var(dim=axis, keepdim=True, unbiased=False)
    return (x - m) / torch.sqrt(v + eps)
def _scatter_add(tgt, idx, src, axis=0):
    return tgt.clone().index_add_(axis, idx, src)
def _segment_sum(src, seg, n):
    out = torch.zeros((n,) + src.shape[1:], dtype=src.dtype)
    return out.index_add_(0, seg, src)
def _pad(x, pw):
    flat = tuple(v for pair in reversed(pw) for v in pair)
    return torch.nn.functional.pad(x, flat)

kernel_name = 'gated_mix__compressed_kv_cla__dense_activation_mish__decode'

def setup_inputs():

    _w = (lambda a: (lambda t: t.to(torch.bfloat16) if t.is_floating_point() else t)(torch.as_tensor(a)))
    def _A_setup():
        B, H, Sq, Sk, D, M = 4, 32, 1, 4096, 128, 512
        Dc = 4 * D
        return {
            "x": _w((lambda *s: torch.randn(*s, dtype=torch.bfloat16) * 0.05)(B, Sq, M)),
            "c_kv": _w((lambda *s: torch.randn(*s, dtype=torch.bfloat16) * 0.4)(B, Sk, Dc)),
            "w_q": _w((lambda *s: torch.randn(*s, dtype=torch.bfloat16) * 12.8)(M, H, D) * (M ** -0.5)),
            "w_uk": _w((lambda *s: torch.randn(*s, dtype=torch.bfloat16) * 12.8)(Dc, H, D) * (Dc ** -0.5)),
            "w_uv": _w((lambda *s: torch.randn(*s, dtype=torch.bfloat16) * 0.4)(Dc, H, D) * (Dc ** -0.5)),
            "w_o": _w((lambda *s: torch.randn(*s, dtype=torch.bfloat16) * 0.4)(H, D, M) * ((H * D) ** -0.5)),
        }
    _A_in = _A_setup()

    def _B_setup():
        B, S, D, F = 4, 1, 512, 1376
        return {
            "x": _w((lambda *s: torch.randn(*s, dtype=torch.bfloat16) * 0.05)(B, S, D)),
            "w1": _w((lambda *s: torch.randn(*s, dtype=torch.bfloat16) * 12.8)(D, F) * (D ** -0.5)),
            "b1": _w((lambda *s: torch.randn(*s, dtype=torch.bfloat16) * 0.2)(F)),
            "w2": _w((lambda *s: torch.randn(*s, dtype=torch.bfloat16) * 0.05)(F, D) * (F ** -0.5)),
        }
    _B_in = _B_setup()

    return {
        "A_x": _A_in["x"],
        "A_c_kv": _A_in["c_kv"],
        "A_w_q": _A_in["w_q"],
        "A_w_uk": _A_in["w_uk"],
        "A_w_uv": _A_in["w_uv"],
        "A_w_o": _A_in["w_o"],
        "B_x": _B_in["x"],
        "B_w1": _B_in["w1"],
        "B_b1": _B_in["b1"],
        "B_w2": _B_in["w2"],
        "gate_w": _w((lambda *s: torch.randn(*s, dtype=torch.bfloat16) * 0.05)(512) * 16.0),
    }

def reference(A_x, A_c_kv, A_w_q, A_w_uk, A_w_uv, A_w_o, B_x, B_w1, B_b1, B_w2, gate_w):
    def _A_ref(x, c_kv, w_q, w_uk, w_uv, w_o):
        B, Sq, M = x.shape[0], x.shape[1], x.shape[2]
        Sk = c_kv.shape[1]
        H, D = w_q.shape[1], w_q.shape[2]
        q = torch.einsum("bqm,mhd->bhqd", x, w_q)
        k = torch.einsum("bkc,chd->bhkd", c_kv, w_uk)
        v = torch.einsum("bkc,chd->bhkd", c_kv, w_uv)
        scores = torch.einsum("bhqd,bhkd->bhqk", q, k) * (D ** -0.5)
        off = Sk - Sq
        qi = torch.arange(Sq)[:, None]
        kj = torch.arange(Sk)[None, :]
        cmask = kj <= (qi + off)
        scores = torch.where(cmask[None, None], scores, -1e9)
        p = _softmax(scores, axis=-1)
        ctx = torch.einsum("bhqk,bhkd->bhqd", p, v)
        return torch.einsum("bhqd,hdm->bqm", ctx, w_o)

    def _B_ref(x, w1, b1, w2):
        h = torch.einsum("bsd,df->bsf", x, w1) + b1
        sp = torch.log1p(torch.exp(-torch.abs(h))) + torch.where(h > 0, h, torch.zeros_like(h))
        act = h * torch.tanh(sp)
        return torch.einsum("bsf,fd->bsd", act, w2)

    x = A_x
    g = _sigmoid((x * gate_w).sum(-1, keepdims=True))
    a = _A_ref(x, A_c_kv, A_w_q, A_w_uk, A_w_uv, A_w_o)
    b = _B_ref(x, B_w1, B_b1, B_w2)
    return g * a + (1 - g) * b
```

```asm
; @launch grid=(256,1,1) block=(512,1,1) lds=161792
.amdgcn_target "amdgcn-amd-amdhsa--gfx950"
.text
.globl gated_mix__compressed_kv_cla__dense_activation_mish__decode_kernel
.p2align 8
.type gated_mix__compressed_kv_cla__dense_activation_mish__decode_kernel,@function
gated_mix__compressed_kv_cla__dense_activation_mish__decode_kernel:
    s_cmp_ge_u32 s2, 256
    s_cbranch_scc1 L_exit
    s_load_dwordx2 s[8:9], s[0:1], 0
    s_load_dwordx2 s[16:17], s[0:1], 16
    s_load_dwordx2 s[20:21], s[0:1], 24
    s_load_dwordx2 s[52:53], s[0:1], 104
    s_load_dwordx2 s[12:13], s[0:1], 8
    s_load_dwordx2 s[24:25], s[0:1], 32
    s_load_dwordx2 s[28:29], s[0:1], 40
    s_load_dwordx2 s[32:33], s[0:1], 56
    s_load_dwordx2 s[36:37], s[0:1], 64
    s_load_dwordx2 s[40:41], s[0:1], 72
    s_load_dwordx2 s[44:45], s[0:1], 80
    s_load_dwordx2 s[48:49], s[0:1], 88
    v_lshrrev_b32 v4, 6, v0
    v_and_b32 v0, 63, v0
    v_readfirstlane_b32 s56, v4
    v_and_b32 v1, 15, v0
    v_lshrrev_b32 v2, 4, v0
    s_and_b32 s57, s2, 7
    s_lshr_b32 s58, s2, 3
    s_and_b32 s59, s58, 1
    s_bfe_u32 s60, s58, 0x30001
    s_lshr_b32 s66, s58, 4
    s_lshl_b32 s67, s57, 1
    s_add_u32 s67, s67, s66
    s_lshl_b32 s66, s59, 4
    s_add_u32 s61, s66, s67
    s_mov_b32 s10, 0x1000
    s_mov_b32 s11, 0x20000
    s_mov_b32 s18, 0x400000
    s_mov_b32 s19, 0x20000
    s_mov_b32 s22, 0x400000
    s_mov_b32 s23, 0x20000
    s_mov_b32 s54, 0x10000000
    s_mov_b32 s55, 0x20000
    s_cmp_lg_u32 s56, 0
    s_cbranch_scc1 L_pro2
    v_lshrrev_b32 v40, 2, v1
    v_lshlrev_b32 v40, 10, v40
    v_lshl_add_u32 v40, v2, 5, v40
    s_lshl_b32 s66, s60, 7
    v_add_u32 v40, s66, v40
    s_lshl_b32 s66, s60, 19
    s_lshl_b32 s67, s61, 8
    s_add_u32 s66, s66, s67
    v_lshlrev_b32 v41, 17, v2
    v_lshl_add_u32 v41, v1, 4, v41
    v_add_u32 v41, s66, v41
    v_lshrrev_b32 v42, 2, v1
    v_lshlrev_b32 v42, 4, v42
    v_and_b32 v43, 3, v1
    v_add_u32 v42, v42, v43
    v_lshlrev_b32 v42, 13, v42
    v_lshl_add_u32 v42, v2, 4, v42
    v_add_u32 v42, s66, v42
    v_mov_b32 v45, 0x0
    s_waitcnt lgkmcnt(0)
    s_mov_b32 s68, 0
    buffer_load_dwordx4 v[128:131], v41, s[16:19], s68 offen nt
    s_add_u32 s68, s68, 8192
    buffer_load_dwordx4 v[132:135], v41, s[16:19], s68 offen nt
    s_add_u32 s68, s68, 8192
    buffer_load_dword v44, v45, s[52:55], 0 offen sc1
    buffer_load_dwordx4 v[8:11], v40, s[8:11], 0 offen offset:0
    buffer_load_dwordx4 v[12:15], v40, s[8:11], 0 offen offset:16
    buffer_load_dwordx4 v[136:139], v41, s[16:19], s68 offen nt
    s_add_u32 s68, s68, 8192
    buffer_load_dwordx4 v[140:143], v41, s[16:19], s68 offen nt
    s_add_u32 s68, s68, 8192
    buffer_load_dwordx4 v[144:147], v41, s[16:19], s68 offen nt
    s_add_u32 s68, s68, 8192
    buffer_load_dwordx4 v[148:151], v41, s[16:19], s68 offen nt
    s_add_u32 s68, s68, 8192
    buffer_load_dwordx4 v[152:155], v41, s[16:19], s68 offen nt
    s_add_u32 s68, s68, 8192
    buffer_load_dwordx4 v[156:159], v41, s[16:19], s68 offen nt
    s_add_u32 s68, s68, 8192
    buffer_load_dwordx4 v[160:163], v41, s[16:19], s68 offen nt
    s_add_u32 s68, s68, 8192
    buffer_load_dwordx4 v[164:167], v41, s[16:19], s68 offen nt
    s_add_u32 s68, s68, 8192
    buffer_load_dwordx4 v[168:171], v41, s[16:19], s68 offen nt
    s_add_u32 s68, s68, 8192
    buffer_load_dwordx4 v[172:175], v41, s[16:19], s68 offen nt
    s_add_u32 s68, s68, 8192
    buffer_load_dwordx4 v[176:179], v41, s[16:19], s68 offen nt
    s_add_u32 s68, s68, 8192
    buffer_load_dwordx4 v[180:183], v41, s[16:19], s68 offen nt
    s_add_u32 s68, s68, 8192
    buffer_load_dwordx4 v[184:187], v41, s[16:19], s68 offen nt
    s_add_u32 s68, s68, 8192
    buffer_load_dwordx4 v[188:191], v41, s[16:19], s68 offen nt
    s_mov_b32 s68, 0
    buffer_load_dwordx4 v[64:67], v42, s[20:23], s68 offen offset:0 nt
    buffer_load_dwordx4 v[68:71], v42, s[20:23], s68 offen offset:64 nt
    buffer_load_dwordx4 v[72:75], v42, s[20:23], s68 offen offset:128 nt
    buffer_load_dwordx4 v[76:79], v42, s[20:23], s68 offen offset:192 nt
    s_add_u32 s68, s68, 32768
    buffer_load_dwordx4 v[80:83], v42, s[20:23], s68 offen offset:0 nt
    buffer_load_dwordx4 v[84:87], v42, s[20:23], s68 offen offset:64 nt
    buffer_load_dwordx4 v[88:91], v42, s[20:23], s68 offen offset:128 nt
    buffer_load_dwordx4 v[92:95], v42, s[20:23], s68 offen offset:192 nt
    s_add_u32 s68, s68, 32768
    buffer_load_dwordx4 v[96:99], v42, s[20:23], s68 offen offset:0 nt
    buffer_load_dwordx4 v[100:103], v42, s[20:23], s68 offen offset:64 nt
    buffer_load_dwordx4 v[104:107], v42, s[20:23], s68 offen offset:128 nt
    buffer_load_dwordx4 v[108:111], v42, s[20:23], s68 offen offset:192 nt
    s_add_u32 s68, s68, 32768
    buffer_load_dwordx4 v[112:115], v42, s[20:23], s68 offen offset:0 nt
    buffer_load_dwordx4 v[116:119], v42, s[20:23], s68 offen offset:64 nt
    buffer_load_dwordx4 v[120:123], v42, s[20:23], s68 offen offset:128 nt
    buffer_load_dwordx4 v[124:127], v42, s[20:23], s68 offen offset:192 nt
L_pro2:
    v_mov_b32 v3, 153664
    v_lshl_add_u32 v40, v1, 2, v3
    v_mov_b32 v41, 0
    ds_write_b32 v40, v41
    v_mov_b32 v42, -1
    v_mov_b32 v43, -1
    v_lshlrev_b32 v40, 3, v0
    v_add_u32 v41, 153088, v40
    ds_write_b64 v41, v[42:43]
    v_add_u32 v41, 158208, v40
    ds_write_b64 v41, v[42:43]
    s_lshl_b32 s100, s61, 3
    s_add_u32 s100, s100, s60
    s_lshr_b32 s62, s57, 1
    s_and_b32 s66, s57, 1
    s_lshl_b32 s66, s66, 4
    s_lshr_b32 s67, s58, 1
    s_add_u32 s63, s66, s67
    s_mov_b32 s14, 0x1000000
    s_mov_b32 s15, 0x20000
    s_mov_b32 s26, 0x400000
    s_mov_b32 s27, 0x20000
    s_mov_b32 s30, 0x400000
    s_mov_b32 s31, 0x20000
    s_mov_b32 s34, 0x158000
    s_mov_b32 s35, 0x20000
    s_mov_b32 s38, 0xac0
    s_mov_b32 s39, 0x20000
    s_mov_b32 s42, 0x158000
    s_mov_b32 s43, 0x20000
    s_mov_b32 s46, 0x400
    s_mov_b32 s47, 0x20000
    s_mov_b32 s50, 0x1000
    s_mov_b32 s51, 0x20000
    s_mov_b32 s3, 0x600000
    s_waitcnt lgkmcnt(0)
    s_barrier
    s_cmp_ge_u32 s56, 4
    s_cbranch_scc1 L_Lpath
    s_setprio 3
    s_cmp_eq_u32 s56, 0
    s_cbranch_scc1 L_q
    v_mov_b32 v43, 0x0
    buffer_load_dword v44, v43, s[52:55], 0 offen sc1
    s_branch L_noq
L_q:
    v_and_b32 v40, 3, v1
    v_mov_b32 v41, 0x0c0c0c0c
    v_mov_b32 v42, 0xc0c0100
    v_cmp_eq_u32 vcc, 0, v40
    s_nop 1
    v_cndmask_b32 v4, v41, v42, vcc
    v_mov_b32 v42, 0x1000c0c
    v_cmp_eq_u32 vcc, 1, v40
    s_nop 1
    v_cndmask_b32 v4, v4, v42, vcc
    v_mov_b32 v42, 0xc0c0100
    v_cmp_eq_u32 vcc, 2, v40
    s_nop 1
    v_cndmask_b32 v5, v41, v42, vcc
    v_mov_b32 v42, 0x1000c0c
    v_cmp_eq_u32 vcc, 3, v40
    s_nop 1
    v_cndmask_b32 v5, v5, v42, vcc
    v_mov_b32 v42, 0xc0c0302
    v_cmp_eq_u32 vcc, 0, v40
    s_nop 1
    v_cndmask_b32 v6, v41, v42, vcc
    v_mov_b32 v42, 0x3020c0c
    v_cmp_eq_u32 vcc, 1, v40
    s_nop 1
    v_cndmask_b32 v6, v6, v42, vcc
    v_mov_b32 v42, 0xc0c0302
    v_cmp_eq_u32 vcc, 2, v40
    s_nop 1
    v_cndmask_b32 v7, v41, v42, vcc
    v_mov_b32 v42, 0x3020c0c
    v_cmp_eq_u32 vcc, 3, v40
    s_nop 1
    v_cndmask_b32 v7, v7, v42, vcc
    v_and_b32 v46, 3, v1
    v_lshrrev_b32 v47, 2, v1
    v_mov_b32 v48, 0
    v_mov_b32 v49, 0x3f80
    v_cmp_eq_u32 vcc, 0, v46
    s_nop 1
    v_cndmask_b32 v50, v48, v49, vcc
    v_mov_b32 v49, 0x3f800000
    v_cmp_eq_u32 vcc, 1, v46
    s_nop 1
    v_cndmask_b32 v50, v50, v49, vcc
    v_mov_b32 v49, 0x3f80
    v_cmp_eq_u32 vcc, 2, v46
    s_nop 1
    v_cndmask_b32 v51, v48, v49, vcc
    v_mov_b32 v49, 0x3f800000
    v_cmp_eq_u32 vcc, 3, v46
    s_nop 1
    v_cndmask_b32 v51, v51, v49, vcc
    v_cmp_eq_u32 vcc, 0, v47
    s_nop 1
    v_cndmask_b32 v192, v48, v50, vcc
    v_cndmask_b32 v193, v48, v51, vcc
    v_mov_b32 v194, v192
    v_mov_b32 v195, v193
    v_cmp_eq_u32 vcc, 1, v47
    s_nop 1
    v_cndmask_b32 v196, v48, v50, vcc
    v_cndmask_b32 v197, v48, v51, vcc
    v_mov_b32 v198, v196
    v_mov_b32 v199, v197
    v_cmp_eq_u32 vcc, 2, v47
    s_nop 1
    v_cndmask_b32 v200, v48, v50, vcc
    v_cndmask_b32 v201, v48, v51, vcc
    v_mov_b32 v202, v200
    v_mov_b32 v203, v201
    v_cmp_eq_u32 vcc, 3, v47
    s_nop 1
    v_cndmask_b32 v204, v48, v50, vcc
    v_cndmask_b32 v205, v48, v51, vcc
    v_mov_b32 v206, v204
    v_mov_b32 v207, v205
    s_lshl_b32 s66, s100, 10
    s_add_u32 s66, s66, 0x10000
    v_lshl_add_u32 v52, v0, 4, s66
    s_lshl_b32 s66, s100, 3
    s_add_u32 s66, s66, 0x50000
    v_mov_b32 v53, s66
    s_lshl_b32 s66, s61, 13
    s_add_u32 s66, s66, 0x10000
    v_lshlrev_b32 v46, 10, v2
    v_lshl_add_u32 v46, v1, 4, v46
    v_add_u32 v54, s66, v46
    v_add_u32 v55, 4096, v54
    s_lshl_b32 s66, s61, 6
    s_add_u32 s66, s66, 0x50000
    v_lshl_add_u32 v46, v0, 3, s66
    v_cmp_gt_u32 s[4:5], 8, v0
    v_mov_b32 v47, 0x7ffffff0
    s_nop 0
    v_cndmask_b32 v56, v47, v46, s[4:5]
    v_lshl_add_u32 v58, v1, 5, s61
    v_lshlrev_b32 v59, 3, v58
    v_add_u32 v59, s60, v59
    v_lshlrev_b32 v59, 3, v59
    v_add_u32 v59, 0x80000, v59
    v_lshlrev_b32 v58, 10, v58
    v_lshl_add_u32 v58, v2, 5, v58
    s_lshl_b32 s66, s60, 7
    s_add_u32 s66, s66, 0x60000
    v_add_u32 v58, s66, v58
    v_lshlrev_b32 v57, 4, v0
    v_add_u32 v57, 152064, v57
    v_and_b32 v248, 3, v1
    v_lshlrev_b32 v248, 8, v248
    v_lshl_add_u32 v248, v2, 4, v248
    v_add_u32 v248, 152064, v248
    s_waitcnt vmcnt(30)
    v_readfirstlane_b32 s65, v44
    s_mul_i32 s64, s65, 0x9e3779b1
    s_add_u32 s64, s64, 0x7f4a7c15
    v_perm_b32 v24, v8, v8, v4
    v_perm_b32 v25, v8, v8, v5
    v_perm_b32 v26, v8, v8, v6
    v_perm_b32 v27, v8, v8, v7
    s_waitcnt vmcnt(30)
    v_swap_b32 v130, v132
    v_swap_b32 v131, v133
    v_perm_b32 v28, v9, v9, v4
    v_perm_b32 v29, v9, v9, v5
    v_perm_b32 v30, v9, v9, v6
    v_perm_b32 v31, v9, v9, v7
    v_mfma_f32_16x16x32_bf16 v[32:35], v[24:27], v[128:131], 0
    v_mfma_f32_16x16x32_bf16 v[36:39], v[24:27], v[132:135], 0
    s_waitcnt vmcnt(28)
    v_swap_b32 v138, v140
    v_swap_b32 v139, v141
    v_perm_b32 v24, v10, v10, v4
    v_perm_b32 v25, v10, v10, v5
    v_perm_b32 v26, v10, v10, v6
    v_perm_b32 v27, v10, v10, v7
    v_mfma_f32_16x16x32_bf16 v[32:35], v[28:31], v[136:139], v[32:35]
    v_mfma_f32_16x16x32_bf16 v[36:39], v[28:31], v[140:143], v[36:39]
    s_waitcnt vmcnt(26)
    v_swap_b32 v146, v148
    v_swap_b32 v147, v149
    v_perm_b32 v28, v11, v11, v4
    v_perm_b32 v29, v11, v11, v5
    v_perm_b32 v30, v11, v11, v6
    v_perm_b32 v31, v11, v11, v7
    v_mfma_f32_16x16x32_bf16 v[32:35], v[24:27], v[144:147], v[32:35]
    v_mfma_f32_16x16x32_bf16 v[36:39], v[24:27], v[148:151], v[36:39]
    s_waitcnt vmcnt(24)
    v_swap_b32 v154, v156
    v_swap_b32 v155, v157
    v_perm_b32 v24, v12, v12, v4
    v_perm_b32 v25, v12, v12, v5
    v_perm_b32 v26, v12, v12, v6
    v_perm_b32 v27, v12, v12, v7
    v_mfma_f32_16x16x32_bf16 v[32:35], v[28:31], v[152:155], v[32:35]
    v_mfma_f32_16x16x32_bf16 v[36:39], v[28:31], v[156:159], v[36:39]
    s_waitcnt vmcnt(22)
    v_swap_b32 v162, v164
    v_swap_b32 v163, v165
    v_perm_b32 v28, v13, v13, v4
    v_perm_b32 v29, v13, v13, v5
    v_perm_b32 v30, v13, v13, v6
    v_perm_b32 v31, v13, v13, v7
    v_mfma_f32_16x16x32_bf16 v[32:35], v[24:27], v[160:163], v[32:35]
    v_mfma_f32_16x16x32_bf16 v[36:39], v[24:27], v[164:167], v[36:39]
    s_waitcnt vmcnt(20)
    v_swap_b32 v170, v172
    v_swap_b32 v171, v173
    v_perm_b32 v24, v14, v14, v4
    v_perm_b32 v25, v14, v14, v5
    v_perm_b32 v26, v14, v14, v6
    v_perm_b32 v27, v14, v14, v7
    v_mfma_f32_16x16x32_bf16 v[32:35], v[28:31], v[168:171], v[32:35]
    v_mfma_f32_16x16x32_bf16 v[36:39], v[28:31], v[172:175], v[36:39]
    s_waitcnt vmcnt(18)
    v_swap_b32 v178, v180
    v_swap_b32 v179, v181
    v_perm_b32 v28, v15, v15, v4
    v_perm_b32 v29, v15, v15, v5
    v_perm_b32 v30, v15, v15, v6
    v_perm_b32 v31, v15, v15, v7
    v_mfma_f32_16x16x32_bf16 v[32:35], v[24:27], v[176:179], v[32:35]
    v_mfma_f32_16x16x32_bf16 v[36:39], v[24:27], v[180:183], v[36:39]
    s_waitcnt vmcnt(16)
    v_swap_b32 v186, v188
    v_swap_b32 v187, v189
    s_nop 1
    v_mfma_f32_16x16x32_bf16 v[32:35], v[28:31], v[184:187], v[32:35]
    v_mfma_f32_16x16x32_bf16 v[36:39], v[28:31], v[188:191], v[36:39]
    s_nop 6
    v_cvt_pk_bf16_f32 v242, v32, v33
    v_cvt_pk_bf16_f32 v243, v34, v35
    v_cvt_pk_bf16_f32 v244, v36, v37
    v_cvt_pk_bf16_f32 v245, v38, v39
    buffer_store_dwordx4 v[242:245], v52, s[52:55], 0 offen
    v_add3_u32 v46, v242, v243, v244
    v_add_u32 v46, v46, v245
    s_nop 1
    v_add_u32_dpp v46, v46, v46 quad_perm:[1,0,3,2] row_mask:0xf bank_mask:0xf
    s_nop 1
    v_add_u32_dpp v46, v46, v46 quad_perm:[2,3,0,1] row_mask:0xf bank_mask:0xf
    s_nop 1
    v_add_u32_dpp v46, v46, v46 row_half_mirror row_mask:0xf bank_mask:0xf
    s_nop 1
    v_add_u32_dpp v46, v46, v46 row_mirror row_mask:0xf bank_mask:0xf
    v_mov_b32 v48, v46
    s_nop 1
    v_permlane16_swap_b32 v46, v48
    v_add_u32 v46, v46, v48
    v_mov_b32 v48, v46
    s_nop 1
    v_permlane32_swap_b32 v46, v48
    v_add_u32 v46, v46, v48
    v_add_u32 v47, s64, v46
    s_mov_b64 s[74:75], exec
    s_mov_b64 exec, 1
    buffer_store_dwordx2 v[46:47], v53, s[52:55], 0 offen
    s_mov_b64 exec, s[74:75]
    v_mov_b32 v246, v46
    v_mov_b32 v247, v47
    v_mov_b32 v43, 1
    s_mov_b64 s[74:75], exec
    s_mov_b64 exec, 1
    ds_add_u32 v3, v43 offset:40
    s_mov_b64 exec, s[74:75]
    s_lshl_b32 s66, s62, 1
    s_add_u32 s66, s66, s59
    s_lshl_b32 s66, s66, 4
    s_lshl_b32 s67, s56, 2
    s_add_u32 s66, s66, s67
    s_lshl_b32 s67, s66, 10
    s_add_u32 s67, s67, 0x60000
    v_lshl_add_u32 v8, v0, 4, s67
    s_lshl_b32 s67, s66, 6
    s_add_u32 s67, s67, 0x80000
    v_lshl_add_u32 v9, v0, 3, s67
    v_cmp_lt_u32 s[76:77], v0, 32
    v_mov_b32 v43, 0x7ffffff0
    s_nop 0
    v_cndmask_b32 v9, v43, v9, s[76:77]
    s_mul_i32 s67, s56, 4224
    s_add_u32 s67, s67, 135168
    v_lshl_add_u32 v10, v0, 4, s67
    s_movk_i32 s67, 1056
    v_mul_lo_u32 v44, v1, s67
    v_lshl_add_u32 v44, v2, 8, v44
    v_and_b32 v45, 1, v2
    v_lshlrev_b32 v45, 4, v45
    v_add_u32 v11, v44, v45
    v_sub_u32 v12, v44, v45
    s_mul_i32 s66, s56, 33792
    v_add_u32 v13, s66, v11
    v_add_u32 v14, s66, v12
    v_add_u32 v11, 135168, v11
    v_add_u32 v12, 135168, v12
    v_lshrrev_b32 v46, 2, v0
    v_mul_lo_u32 v46, v46, s67
    v_and_b32 v47, 3, v0
    v_lshl_add_u32 v46, v47, 3, v46
    s_lshl_b32 s66, s56, 8
    v_add_u32 v15, s66, v46
    v_add_u32 v16, 67584, v15
    v_lshlrev_b32 v17, 4, v1
    v_add_u32 v17, 153088, v17
    s_lshl_b32 s66, s56, 2
    v_add_u32 v18, s66, v17
    v_lshlrev_b32 v19, 4, v0
    v_add_u32 v19, 154112, v19
    s_lshl_b32 s66, s56, 10
    v_add_u32 v20, s66, v19
    s_lshl_b32 s66, s59, 4
    v_add_u32 v48, s66, v1
    s_lshl_b32 s66, s56, 3
    s_add_u32 s66, s66, s63
    v_add_u32 v50, s66, v48
    v_add_u32 v51, 4, v50
    v_and_b32 v50, 31, v50
    v_and_b32 v51, 31, v51
    v_lshlrev_b32 v48, 10, v48
    s_lshl_b32 s66, s56, 8
    s_lshl_b32 s67, s62, 5
    s_add_u32 s66, s66, s67
    v_add_u32 v48, s66, v48
    v_add_u32 v50, v48, v50
    v_add3_u32 v51, v48, v51, 64
    v_add_u32 v51, 64, v51
    v_and_b32 v49, 1, v2
    v_lshlrev_b32 v49, 1, v49
    v_lshrrev_b32 v45, 1, v2
    v_add_u32 v49, v49, v45
    v_lshlrev_b32 v49, 4, v49
    v_lshl_add_u32 v21, v50, 7, v49
    v_add_u32 v21, 0x200000, v21
    v_lshl_add_u32 v22, v51, 7, v49
    v_add_u32 v22, 0x200000, v22
    v_cmp_eq_u32 vcc, 1, v2
    s_nop 1
    v_cndmask_b32 v50, v50, v51, vcc
    v_lshlrev_b32 v50, 4, v50
    v_add_u32 v23, 0x140000, v50
    s_mov_b32 s101, 0
    s_mov_b32 s72, 0
L_hop1_1:
    s_cmp_lg_u32 s72, 8
    s_cbranch_scc1 L_nosw_2
    buffer_store_dwordx4 v[242:245], v52, s[52:55], s3 offen sc1
    s_mov_b64 s[74:75], exec
    s_mov_b64 exec, 1
    buffer_store_dwordx2 v[246:247], v53, s[52:55], s3 offen sc1
    s_mov_b64 exec, s[74:75]
L_nosw_2:
    s_cmp_ge_u32 s72, 8
    s_cselect_b32 s101, s3, 0
    buffer_load_dwordx4 v[208:211], v54, s[52:55], s101 offen offset:0 sc1
    buffer_load_dwordx4 v[212:215], v55, s[52:55], s101 offen offset:0 sc1
    buffer_load_dwordx4 v[216:219], v54, s[52:55], s101 offen offset:256 sc1
    buffer_load_dwordx4 v[220:223], v55, s[52:55], s101 offen offset:256 sc1
    buffer_load_dwordx4 v[224:227], v54, s[52:55], s101 offen offset:512 sc1
    buffer_load_dwordx4 v[228:231], v55, s[52:55], s101 offen offset:512 sc1
    buffer_load_dwordx4 v[232:235], v54, s[52:55], s101 offen offset:768 sc1
    buffer_load_dwordx4 v[236:239], v55, s[52:55], s101 offen offset:768 sc1
    buffer_load_dwordx2 v[240:241], v56, s[52:55], s101 offen sc1
    s_waitcnt vmcnt(0)
    v_add_u32 v47, s64, v240
    v_cmp_ne_u32 vcc, v47, v241
    s_and_b64 s[78:79], vcc, s[4:5]
    v_add3_u32 v46, v208, v209, v210
    v_add3_u32 v46, v46, v211, v212
    v_add3_u32 v46, v46, v213, v214
    v_add3_u32 v46, v46, v215, v216
    v_add3_u32 v46, v46, v217, v218
    v_add3_u32 v46, v46, v219, v220
    v_add3_u32 v46, v46, v221, v222
    v_add_u32 v46, v46, v223
    v_add3_u32 v47, v224, v225, v226
    v_add3_u32 v47, v47, v227, v228
    v_add3_u32 v47, v47, v229, v230
    v_add3_u32 v47, v47, v231, v232
    v_add3_u32 v47, v47, v233, v234
    v_add3_u32 v47, v47, v235, v236
    v_add3_u32 v47, v47, v237, v238
    v_add_u32 v47, v47, v239
    v_add_u32 v46, v46, v47
    v_sub_u32 v46, v46, v240
    s_nop 1
    v_add_u32_dpp v46, v46, v46 quad_perm:[1,0,3,2] row_mask:0xf bank_mask:0xf
    v_swap_b32 v210, v212
    v_swap_b32 v211, v213
    v_add_u32_dpp v46, v46, v46 quad_perm:[2,3,0,1] row_mask:0xf bank_mask:0xf
    v_swap_b32 v218, v220
    v_swap_b32 v219, v221
    v_add_u32_dpp v46, v46, v46 row_half_mirror row_mask:0xf bank_mask:0xf
    v_swap_b32 v226, v228
    v_swap_b32 v227, v229
    v_add_u32_dpp v46, v46, v46 row_mirror row_mask:0xf bank_mask:0xf
    v_mov_b32 v48, v46
    v_swap_b32 v234, v236
    v_swap_b32 v235, v237
    v_permlane16_swap_b32 v46, v48
    v_add_u32 v46, v46, v48
    v_mov_b32 v48, v46
    v_mfma_f32_16x16x32_bf16 v[32:35], v[192:195], v[208:211], 0
    v_mfma_f32_16x16x32_bf16 v[36:39], v[192:195], v[212:215], 0
    v_permlane32_swap_b32 v46, v48
    v_add_u32 v46, v46, v48
    v_mfma_f32_16x16x32_bf16 v[32:35], v[196:199], v[216:219], v[32:35]
    v_mfma_f32_16x16x32_bf16 v[36:39], v[196:199], v[220:223], v[36:39]
    v_mfma_f32_16x16x32_bf16 v[32:35], v[200:203], v[224:227], v[32:35]
    v_mfma_f32_16x16x32_bf16 v[36:39], v[200:203], v[228:231], v[36:39]
    v_mfma_f32_16x16x32_bf16 v[32:35], v[204:207], v[232:235], v[32:35]
    v_mfma_f32_16x16x32_bf16 v[36:39], v[204:207], v[236:239], v[36:39]
    v_cmp_ne_u32 vcc, 0, v46
    s_or_b64 s[78:79], s[78:79], vcc
    s_cmp_eq_u64 s[78:79], 0
    s_cbranch_scc1 done_3
    s_add_u32 s72, s72, 1
    s_cmp_lt_u32 s72, 20000
    s_cbranch_scc1 L_hop1_1
done_3:
    s_mov_b32 s101, s72
    v_cvt_pk_bf16_f32 v60, v32, v33
    v_cvt_pk_bf16_f32 v61, v34, v35
    v_cvt_pk_bf16_f32 v62, v36, v37
    v_cvt_pk_bf16_f32 v63, v38, v39
    ds_write_b128 v57, v[60:63]
    ds_read_b128 v[128:131], v248 offset:0
    ds_read_b128 v[132:135], v248 offset:64
    ds_read_b128 v[136:139], v248 offset:128
    ds_read_b128 v[140:143], v248 offset:192
    s_waitcnt lgkmcnt(3)
    v_mfma_f32_16x16x32_bf16 v[144:147], v[64:67], v[128:131], 0
    v_mfma_f32_16x16x32_bf16 v[148:151], v[80:83], v[128:131], 0
    v_mfma_f32_16x16x32_bf16 v[152:155], v[96:99], v[128:131], 0
    v_mfma_f32_16x16x32_bf16 v[156:159], v[112:115], v[128:131], 0
    s_waitcnt lgkmcnt(2)
    v_mfma_f32_16x16x32_bf16 v[144:147], v[68:71], v[132:135], v[144:147]
    v_mfma_f32_16x16x32_bf16 v[148:151], v[84:87], v[132:135], v[148:151]
    v_mfma_f32_16x16x32_bf16 v[152:155], v[100:103], v[132:135], v[152:155]
    v_mfma_f32_16x16x32_bf16 v[156:159], v[116:119], v[132:135], v[156:159]
    s_waitcnt lgkmcnt(1)
    v_mfma_f32_16x16x32_bf16 v[144:147], v[72:75], v[136:139], v[144:147]
    v_mfma_f32_16x16x32_bf16 v[148:151], v[88:91], v[136:139], v[148:151]
    v_mfma_f32_16x16x32_bf16 v[152:155], v[104:107], v[136:139], v[152:155]
    v_mfma_f32_16x16x32_bf16 v[156:159], v[120:123], v[136:139], v[156:159]
    s_waitcnt lgkmcnt(0)
    v_mfma_f32_16x16x32_bf16 v[144:147], v[76:79], v[140:143], v[144:147]
    v_mfma_f32_16x16x32_bf16 v[148:151], v[92:95], v[140:143], v[148:151]
    v_mfma_f32_16x16x32_bf16 v[152:155], v[108:111], v[140:143], v[152:155]
    v_mfma_f32_16x16x32_bf16 v[156:159], v[124:127], v[140:143], v[156:159]
    s_nop 4
    v_cvt_pk_bf16_f32 v160, v144, v145
    v_cvt_pk_bf16_f32 v161, v146, v147
    v_cvt_pk_bf16_f32 v162, v148, v149
    v_cvt_pk_bf16_f32 v163, v150, v151
    v_cvt_pk_bf16_f32 v164, v152, v153
    v_cvt_pk_bf16_f32 v165, v154, v155
    v_cvt_pk_bf16_f32 v166, v156, v157
    v_cvt_pk_bf16_f32 v167, v158, v159
    s_mov_b64 s[74:75], exec
    s_mov_b32 exec_lo, 0x000f000f
    s_mov_b32 exec_hi, 0x000f000f
    buffer_store_dwordx4 v[160:163], v58, s[52:55], 0 offen sc1
    buffer_store_dwordx4 v[164:167], v58, s[52:55], 0 offen offset:16 sc1
    s_mov_b64 exec, s[74:75]
    v_add3_u32 v44, v160, v161, v162
    v_add3_u32 v44, v44, v163, v164
    v_add3_u32 v44, v44, v165, v166
    v_add_u32 v44, v44, v167
    v_mov_b32 v46, v44
    s_nop 1
    v_permlane16_swap_b32 v44, v46
    v_add_u32 v44, v44, v46
    v_mov_b32 v46, v44
    s_nop 1
    v_permlane32_swap_b32 v44, v46
    v_add_u32 v44, v44, v46
    v_add_u32 v45, s64, v44
    s_mov_b64 exec, 0xf
    buffer_store_dwordx2 v[44:45], v59, s[52:55], 0 offen sc1
    s_mov_b64 exec, s[74:75]
    s_cmp_ge_u32 s101, 8
    s_cbranch_scc1 L_nocp_4
    buffer_store_dwordx4 v[242:245], v52, s[52:55], s3 offen sc1
    s_mov_b64 s[74:75], exec
    s_mov_b64 exec, 1
    buffer_store_dwordx2 v[246:247], v53, s[52:55], s3 offen sc1
    s_mov_b64 exec, s[74:75]
L_nocp_4:
    s_waitcnt vmcnt(0)
    v_mov_b32 v43, 1
    s_mov_b64 s[74:75], exec
    s_mov_b64 exec, 1
    ds_add_u32 v3, v43 offset:28
    s_mov_b64 exec, s[74:75]
    s_branch L_qdone
L_noq:
    v_and_b32 v40, 3, v1
    v_mov_b32 v41, 0x0c0c0c0c
    v_mov_b32 v42, 0xc0c0100
    v_cmp_eq_u32 vcc, 0, v40
    s_nop 1
    v_cndmask_b32 v4, v41, v42, vcc
    v_mov_b32 v42, 0x1000c0c
    v_cmp_eq_u32 vcc, 1, v40
    s_nop 1
    v_cndmask_b32 v4, v4, v42, vcc
    v_mov_b32 v42, 0xc0c0100
    v_cmp_eq_u32 vcc, 2, v40
    s_nop 1
    v_cndmask_b32 v5, v41, v42, vcc
    v_mov_b32 v42, 0x1000c0c
    v_cmp_eq_u32 vcc, 3, v40
    s_nop 1
    v_cndmask_b32 v5, v5, v42, vcc
    v_mov_b32 v42, 0xc0c0302
    v_cmp_eq_u32 vcc, 0, v40
    s_nop 1
    v_cndmask_b32 v6, v41, v42, vcc
    v_mov_b32 v42, 0x3020c0c
    v_cmp_eq_u32 vcc, 1, v40
    s_nop 1
    v_cndmask_b32 v6, v6, v42, vcc
    v_mov_b32 v42, 0xc0c0302
    v_cmp_eq_u32 vcc, 2, v40
    s_nop 1
    v_cndmask_b32 v7, v41, v42, vcc
    v_mov_b32 v42, 0x3020c0c
    v_cmp_eq_u32 vcc, 3, v40
    s_nop 1
    v_cndmask_b32 v7, v7, v42, vcc
    s_waitcnt vmcnt(0)
    v_readfirstlane_b32 s65, v44
    s_mul_i32 s64, s65, 0x9e3779b1
    s_add_u32 s64, s64, 0x7f4a7c15
    s_lshl_b32 s66, s62, 1
    s_add_u32 s66, s66, s59
    s_lshl_b32 s66, s66, 4
    s_lshl_b32 s67, s56, 2
    s_add_u32 s66, s66, s67
    s_lshl_b32 s67, s66, 10
    s_add_u32 s67, s67, 0x60000
    v_lshl_add_u32 v8, v0, 4, s67
    s_lshl_b32 s67, s66, 6
    s_add_u32 s67, s67, 0x80000
    v_lshl_add_u32 v9, v0, 3, s67
    v_cmp_lt_u32 s[76:77], v0, 32
    v_mov_b32 v43, 0x7ffffff0
    s_nop 0
    v_cndmask_b32 v9, v43, v9, s[76:77]
    s_mul_i32 s67, s56, 4224
    s_add_u32 s67, s67, 135168
    v_lshl_add_u32 v10, v0, 4, s67
    s_movk_i32 s67, 1056
    v_mul_lo_u32 v44, v1, s67
    v_lshl_add_u32 v44, v2, 8, v44
    v_and_b32 v45, 1, v2
    v_lshlrev_b32 v45, 4, v45
    v_add_u32 v11, v44, v45
    v_sub_u32 v12, v44, v45
    s_mul_i32 s66, s56, 33792
    v_add_u32 v13, s66, v11
    v_add_u32 v14, s66, v12
    v_add_u32 v11, 135168, v11
    v_add_u32 v12, 135168, v12
    v_lshrrev_b32 v46, 2, v0
    v_mul_lo_u32 v46, v46, s67
    v_and_b32 v47, 3, v0
    v_lshl_add_u32 v46, v47, 3, v46
    s_lshl_b32 s66, s56, 8
    v_add_u32 v15, s66, v46
    v_add_u32 v16, 67584, v15
    v_lshlrev_b32 v17, 4, v1
    v_add_u32 v17, 153088, v17
    s_lshl_b32 s66, s56, 2
    v_add_u32 v18, s66, v17
    v_lshlrev_b32 v19, 4, v0
    v_add_u32 v19, 154112, v19
    s_lshl_b32 s66, s56, 10
    v_add_u32 v20, s66, v19
    s_lshl_b32 s66, s59, 4
    v_add_u32 v48, s66, v1
    s_lshl_b32 s66, s56, 3
    s_add_u32 s66, s66, s63
    v_add_u32 v50, s66, v48
    v_add_u32 v51, 4, v50
    v_and_b32 v50, 31, v50
    v_and_b32 v51, 31, v51
    v_lshlrev_b32 v48, 10, v48
    s_lshl_b32 s66, s56, 8
    s_lshl_b32 s67, s62, 5
    s_add_u32 s66, s66, s67
    v_add_u32 v48, s66, v48
    v_add_u32 v50, v48, v50
    v_add3_u32 v51, v48, v51, 64
    v_add_u32 v51, 64, v51
    v_and_b32 v49, 1, v2
    v_lshlrev_b32 v49, 1, v49
    v_lshrrev_b32 v45, 1, v2
    v_add_u32 v49, v49, v45
    v_lshlrev_b32 v49, 4, v49
    v_lshl_add_u32 v21, v50, 7, v49
    v_add_u32 v21, 0x200000, v21
    v_lshl_add_u32 v22, v51, 7, v49
    v_add_u32 v22, 0x200000, v22
    v_cmp_eq_u32 vcc, 1, v2
    s_nop 1
    v_cndmask_b32 v50, v50, v51, vcc
    v_lshlrev_b32 v50, 4, v50
    v_add_u32 v23, 0x140000, v50
L_qdone:
    s_mov_b32 s73, 0
L_fw_5:
    ds_read_b32 v44, v3 offset:0
    s_waitcnt lgkmcnt(0)
    v_cmp_gt_u32 vcc, 4, v44
    s_cbranch_vccz L_fd_6
    s_add_u32 s73, s73, 1
    s_cmp_lt_u32 s73, 2000000
    s_cbranch_scc1 L_fw_5
L_fd_6:
    s_mov_b32 s73, 0
L_fw_7:
    ds_read_b32 v44, v3 offset:28
    s_waitcnt lgkmcnt(0)
    v_cmp_gt_u32 vcc, 1, v44
    s_cbranch_vccz L_fd_8
    s_add_u32 s73, s73, 1
    s_cmp_lt_u32 s73, 2000000
    s_cbranch_scc1 L_fw_7
L_fd_8:
    s_mov_b32 s72, 0
L_hop2_9:
    buffer_load_dwordx4 v[64:67], v8, s[52:55], 0 offen offset:0 sc1
    buffer_load_dwordx4 v[68:71], v8, s[52:55], 0 offen offset:1024 sc1
    buffer_load_dwordx4 v[72:75], v8, s[52:55], 0 offen offset:2048 sc1
    buffer_load_dwordx4 v[76:79], v8, s[52:55], 0 offen offset:3072 sc1
    buffer_load_dwordx2 v[80:81], v9, s[52:55], 0 offen sc1
    s_waitcnt vmcnt(0)
    v_add_u32 v45, s64, v80
    v_cmp_ne_u32 vcc, v45, v81
    s_and_b64 s[78:79], vcc, s[76:77]
    v_add3_u32 v44, v64, v65, v66
    v_add3_u32 v44, v44, v67, v68
    v_add3_u32 v44, v44, v69, v70
    v_add3_u32 v44, v44, v71, v72
    v_add3_u32 v44, v44, v73, v74
    v_add3_u32 v44, v44, v75, v76
    v_add3_u32 v44, v44, v77, v78
    v_add_u32 v44, v44, v79
    v_sub_u32 v44, v44, v80
    s_nop 1
    v_add_u32_dpp v44, v44, v44 quad_perm:[1,0,3,2] row_mask:0xf bank_mask:0xf
    ds_write_b128 v10, v[64:67] offset:0
    ds_write_b128 v10, v[68:71] offset:1056
    v_add_u32_dpp v44, v44, v44 quad_perm:[2,3,0,1] row_mask:0xf bank_mask:0xf
    ds_write_b128 v10, v[72:75] offset:2112
    ds_write_b128 v10, v[76:79] offset:3168
    v_add_u32_dpp v44, v44, v44 row_half_mirror row_mask:0xf bank_mask:0xf
    s_nop 1
    v_add_u32_dpp v44, v44, v44 row_mirror row_mask:0xf bank_mask:0xf
    v_mov_b32 v46, v44
    s_nop 1
    v_permlane16_swap_b32 v44, v46
    v_add_u32 v44, v44, v46
    v_mov_b32 v46, v44
    s_nop 1
    v_permlane32_swap_b32 v44, v46
    v_add_u32 v44, v44, v46
    v_cmp_ne_u32 vcc, 0, v44
    s_or_b64 s[78:79], s[78:79], vcc
    s_cmp_eq_u64 s[78:79], 0
    s_cbranch_scc1 done_10
    s_add_u32 s72, s72, 1
    s_cmp_lt_u32 s72, 20000
    s_cbranch_scc1 L_hop2_9
done_10:
    v_mov_b32 v43, 1
    s_mov_b64 s[74:75], exec
    s_mov_b64 exec, 1
    ds_add_u32 v3, v43 offset:8
    s_mov_b64 exec, s[74:75]
    s_mov_b32 s73, 0
L_fw_11:
    ds_read_b32 v44, v3 offset:4
    s_waitcnt lgkmcnt(0)
    v_cmp_gt_u32 vcc, 4, v44
    s_cbranch_vccz L_fd_12
    s_add_u32 s73, s73, 1
    s_cmp_lt_u32 s73, 2000000
    s_cbranch_scc1 L_fw_11
L_fd_12:
    s_mov_b32 s73, 0
L_fw_13:
    ds_read_b32 v44, v3 offset:8
    s_waitcnt lgkmcnt(0)
    v_cmp_gt_u32 vcc, 4, v44
    s_cbranch_vccz L_fd_14
    s_add_u32 s73, s73, 1
    s_cmp_lt_u32 s73, 2000000
    s_cbranch_scc1 L_fw_13
L_fd_14:
    ds_read_b128 v[64:67], v11 offset:0
    ds_read_b128 v[128:131], v13 offset:0
    ds_read_b128 v[132:135], v13 offset:16896
    ds_read_b128 v[68:71], v12 offset:16
    ds_read_b128 v[136:139], v14 offset:16
    ds_read_b128 v[140:143], v14 offset:16912
    ds_read_b128 v[72:75], v11 offset:32
    ds_read_b128 v[144:147], v13 offset:32
    ds_read_b128 v[148:151], v13 offset:16928
    ds_read_b128 v[76:79], v12 offset:48
    ds_read_b128 v[152:155], v14 offset:48
    ds_read_b128 v[156:159], v14 offset:16944
    s_waitcnt lgkmcnt(9)
    v_mfma_f32_16x16x32_bf16 v[32:35], v[128:131], v[64:67], 0
    v_mfma_f32_16x16x32_bf16 v[36:39], v[132:135], v[64:67], 0
    ds_read_b128 v[80:83], v11 offset:64
    ds_read_b128 v[160:163], v13 offset:64
    ds_read_b128 v[164:167], v13 offset:16960
    s_waitcnt lgkmcnt(9)
    v_mfma_f32_16x16x32_bf16 v[32:35], v[136:139], v[68:71], v[32:35]
    v_mfma_f32_16x16x32_bf16 v[36:39], v[140:143], v[68:71], v[36:39]
    ds_read_b128 v[84:87], v12 offset:80
    ds_read_b128 v[168:171], v14 offset:80
    ds_read_b128 v[172:175], v14 offset:16976
    s_waitcnt lgkmcnt(9)
    v_mfma_f32_16x16x32_bf16 v[32:35], v[144:147], v[72:75], v[32:35]
    v_mfma_f32_16x16x32_bf16 v[36:39], v[148:151], v[72:75], v[36:39]
    ds_read_b128 v[88:91], v11 offset:96
    ds_read_b128 v[176:179], v13 offset:96
    ds_read_b128 v[180:183], v13 offset:16992
    s_waitcnt lgkmcnt(9)
    v_mfma_f32_16x16x32_bf16 v[32:35], v[152:155], v[76:79], v[32:35]
    v_mfma_f32_16x16x32_bf16 v[36:39], v[156:159], v[76:79], v[36:39]
    ds_read_b128 v[92:95], v12 offset:112
    ds_read_b128 v[184:187], v14 offset:112
    ds_read_b128 v[188:191], v14 offset:17008
    s_waitcnt lgkmcnt(9)
    v_mfma_f32_16x16x32_bf16 v[32:35], v[160:163], v[80:83], v[32:35]
    v_mfma_f32_16x16x32_bf16 v[36:39], v[164:167], v[80:83], v[36:39]
    ds_read_b128 v[96:99], v11 offset:128
    ds_read_b128 v[128:131], v13 offset:128
    ds_read_b128 v[132:135], v13 offset:17024
    s_waitcnt lgkmcnt(9)
    v_mfma_f32_16x16x32_bf16 v[32:35], v[168:171], v[84:87], v[32:35]
    v_mfma_f32_16x16x32_bf16 v[36:39], v[172:175], v[84:87], v[36:39]
    ds_read_b128 v[100:103], v12 offset:144
    ds_read_b128 v[136:139], v14 offset:144
    ds_read_b128 v[140:143], v14 offset:17040
    s_waitcnt lgkmcnt(9)
    v_mfma_f32_16x16x32_bf16 v[32:35], v[176:179], v[88:91], v[32:35]
    v_mfma_f32_16x16x32_bf16 v[36:39], v[180:183], v[88:91], v[36:39]
    ds_read_b128 v[104:107], v11 offset:160
    ds_read_b128 v[144:147], v13 offset:160
    ds_read_b128 v[148:151], v13 offset:17056
    s_waitcnt lgkmcnt(9)
    v_mfma_f32_16x16x32_bf16 v[32:35], v[184:187], v[92:95], v[32:35]
    v_mfma_f32_16x16x32_bf16 v[36:39], v[188:191], v[92:95], v[36:39]
    ds_read_b128 v[108:111], v12 offset:176
    ds_read_b128 v[152:155], v14 offset:176
    ds_read_b128 v[156:159], v14 offset:17072
    s_waitcnt lgkmcnt(9)
    v_mfma_f32_16x16x32_bf16 v[32:35], v[128:131], v[96:99], v[32:35]
    v_mfma_f32_16x16x32_bf16 v[36:39], v[132:135], v[96:99], v[36:39]
    ds_read_b128 v[112:115], v11 offset:192
    ds_read_b128 v[160:163], v13 offset:192
    ds_read_b128 v[164:167], v13 offset:17088
    s_waitcnt lgkmcnt(9)
    v_mfma_f32_16x16x32_bf16 v[32:35], v[136:139], v[100:103], v[32:35]
    v_mfma_f32_16x16x32_bf16 v[36:39], v[140:143], v[100:103], v[36:39]
    ds_read_b128 v[116:119], v12 offset:208
    ds_read_b128 v[168:171], v14 offset:208
    ds_read_b128 v[172:175], v14 offset:17104
    s_waitcnt lgkmcnt(9)
    v_mfma_f32_16x16x32_bf16 v[32:35], v[144:147], v[104:107], v[32:35]
    v_mfma_f32_16x16x32_bf16 v[36:39], v[148:151], v[104:107], v[36:39]
    ds_read_b128 v[120:123], v11 offset:224
    ds_read_b128 v[176:179], v13 offset:224
    ds_read_b128 v[180:183], v13 offset:17120
    s_waitcnt lgkmcnt(9)
    v_mfma_f32_16x16x32_bf16 v[32:35], v[152:155], v[108:111], v[32:35]
    v_mfma_f32_16x16x32_bf16 v[36:39], v[156:159], v[108:111], v[36:39]
    ds_read_b128 v[124:127], v12 offset:240
    ds_read_b128 v[184:187], v14 offset:240
    ds_read_b128 v[188:191], v14 offset:17136
    s_waitcnt lgkmcnt(9)
    v_mfma_f32_16x16x32_bf16 v[32:35], v[160:163], v[112:115], v[32:35]
    v_mfma_f32_16x16x32_bf16 v[36:39], v[164:167], v[112:115], v[36:39]
    s_waitcnt lgkmcnt(6)
    v_mfma_f32_16x16x32_bf16 v[32:35], v[168:171], v[116:119], v[32:35]
    v_mfma_f32_16x16x32_bf16 v[36:39], v[172:175], v[116:119], v[36:39]
    s_waitcnt lgkmcnt(3)
    v_mfma_f32_16x16x32_bf16 v[32:35], v[176:179], v[120:123], v[32:35]
    v_mfma_f32_16x16x32_bf16 v[36:39], v[180:183], v[120:123], v[36:39]
    s_waitcnt lgkmcnt(0)
    v_mfma_f32_16x16x32_bf16 v[32:35], v[184:187], v[124:127], v[32:35]
    v_mfma_f32_16x16x32_bf16 v[36:39], v[188:191], v[124:127], v[36:39]
    s_nop 6
    v_max3_f32 v44, v32, v33, v34
    v_max3_f32 v45, v35, v36, v37
    v_max3_f32 v44, v44, v38, v39
    v_max_f32 v44, v44, v45
    v_mov_b32 v45, v44
    s_nop 1
    v_permlane16_swap_b32 v44, v45
    v_max_f32 v44, v44, v45
    v_mov_b32 v45, v44
    s_nop 1
    v_permlane32_swap_b32 v44, v45
    v_max_f32 v44, v44, v45
    ds_write_b32 v18, v44
    s_mov_b32 s73, 0
L_mx_15:
    ds_read_b128 v[48:51], v17
    s_waitcnt lgkmcnt(0)
    v_max3_u32 v47, v48, v49, v50
    v_max_u32 v47, v47, v51
    v_cmp_eq_u32 vcc, -1, v47
    s_cbranch_vccz L_mxd_16
    s_add_u32 s73, s73, 1
    s_cmp_lt_u32 s73, 2000000
    s_cbranch_scc1 L_mx_15
L_mxd_16:
    v_max3_f32 v44, v48, v49, v50
    ds_read_b64_tr_b16 v[128:129], v15 offset:0
    ds_read_b64_tr_b16 v[130:131], v15 offset:16896
    ds_read_b64_tr_b16 v[132:133], v15 offset:33792
    ds_read_b64_tr_b16 v[134:135], v15 offset:50688
    ds_read_b64_tr_b16 v[136:137], v16 offset:0
    ds_read_b64_tr_b16 v[138:139], v16 offset:16896
    ds_read_b64_tr_b16 v[140:141], v16 offset:33792
    ds_read_b64_tr_b16 v[142:143], v16 offset:50688
    ds_read_b64_tr_b16 v[144:145], v15 offset:32
    ds_read_b64_tr_b16 v[146:147], v15 offset:16928
    ds_read_b64_tr_b16 v[148:149], v15 offset:33824
    ds_read_b64_tr_b16 v[150:151], v15 offset:50720
    v_max_f32 v44, v44, v51
    s_mov_b32 s66, 0x3e0293ee
    v_mul_f32 v44, s66, v44
    v_fma_f32 v32, v32, s66, -v44
    v_fma_f32 v33, v33, s66, -v44
    v_fma_f32 v34, v34, s66, -v44
    v_fma_f32 v35, v35, s66, -v44
    v_fma_f32 v36, v36, s66, -v44
    v_fma_f32 v37, v37, s66, -v44
    v_fma_f32 v38, v38, s66, -v44
    v_fma_f32 v39, v39, s66, -v44
    v_exp_f32 v32, v32
    v_exp_f32 v33, v33
    v_exp_f32 v34, v34
    v_exp_f32 v35, v35
    v_exp_f32 v36, v36
    v_exp_f32 v37, v37
    v_exp_f32 v38, v38
    v_exp_f32 v39, v39
    v_cvt_pk_bf16_f32 v52, v32, v33
    v_cvt_pk_bf16_f32 v53, v34, v35
    v_cvt_pk_bf16_f32 v54, v36, v37
    v_cvt_pk_bf16_f32 v55, v38, v39
    ds_write_b128 v20, v[52:55]
    v_add_f32 v46, v32, v33
    v_add_f32 v47, v34, v35
    v_add_f32 v48, v36, v37
    v_add_f32 v49, v38, v39
    v_add_f32 v46, v46, v47
    v_add_f32 v48, v48, v49
    v_add_f32 v46, v46, v48
    v_mov_b32 v47, v46
    s_nop 1
    v_permlane16_swap_b32 v46, v47
    v_add_f32 v46, v46, v47
    v_mov_b32 v47, v46
    s_nop 1
    v_permlane32_swap_b32 v46, v47
    v_add_f32 v46, v46, v47
    ds_write_b32 v18, v46 offset:256
    s_mov_b32 s73, 0
L_ls_17:
    ds_read_b128 v[48:51], v17 offset:256
    ds_read_b128 v[64:67], v19 offset:0
    ds_read_b128 v[68:71], v19 offset:1024
    ds_read_b128 v[72:75], v19 offset:2048
    ds_read_b128 v[76:79], v19 offset:3072
    s_waitcnt lgkmcnt(0)
    v_max3_u32 v47, v48, v49, v50
    v_max_u32 v47, v47, v51
    v_cmp_eq_u32 vcc, -1, v47
    s_cbranch_vccz L_lsd_18
    s_add_u32 s73, s73, 1
    s_cmp_lt_u32 s73, 2000000
    s_cbranch_scc1 L_ls_17
L_lsd_18:
    ds_read_b64_tr_b16 v[152:153], v16 offset:32
    ds_read_b64_tr_b16 v[154:155], v16 offset:16928
    ds_read_b64_tr_b16 v[156:157], v16 offset:33824
    ds_read_b64_tr_b16 v[158:159], v16 offset:50720
    ds_read_b64_tr_b16 v[160:161], v15 offset:64
    ds_read_b64_tr_b16 v[162:163], v15 offset:16960
    ds_read_b64_tr_b16 v[164:165], v15 offset:33856
    ds_read_b64_tr_b16 v[166:167], v15 offset:50752
    ds_read_b64_tr_b16 v[168:169], v16 offset:64
    ds_read_b64_tr_b16 v[170:171], v16 offset:16960
    ds_read_b64_tr_b16 v[172:173], v16 offset:33856
    ds_read_b64_tr_b16 v[174:175], v16 offset:50752
    ds_read_b64_tr_b16 v[176:177], v15 offset:96
    ds_read_b64_tr_b16 v[178:179], v15 offset:16992
    v_add_f32 v48, v48, v49
    v_add_f32 v50, v50, v51
    v_add_f32 v47, v48, v50
    s_waitcnt lgkmcnt(13)
    v_mfma_f32_16x16x32_bf16 v[80:83], v[128:131], v[64:67], 0
    ds_read_b64_tr_b16 v[180:181], v15 offset:33888
    ds_read_b64_tr_b16 v[182:183], v15 offset:50784
    s_waitcnt lgkmcnt(13)
    v_mfma_f32_16x16x32_bf16 v[80:83], v[132:135], v[68:71], v[80:83]
    ds_read_b64_tr_b16 v[184:185], v16 offset:96
    ds_read_b64_tr_b16 v[186:187], v16 offset:16992
    s_waitcnt lgkmcnt(13)
    v_mfma_f32_16x16x32_bf16 v[80:83], v[136:139], v[72:75], v[80:83]
    ds_read_b64_tr_b16 v[188:189], v16 offset:33888
    ds_read_b64_tr_b16 v[190:191], v16 offset:50784
    s_waitcnt lgkmcnt(13)
    v_mfma_f32_16x16x32_bf16 v[80:83], v[140:143], v[76:79], v[80:83]
    ds_read_b64_tr_b16 v[128:129], v15 offset:128
    ds_read_b64_tr_b16 v[130:131], v15 offset:17024
    s_waitcnt lgkmcnt(13)
    v_mfma_f32_16x16x32_bf16 v[84:87], v[144:147], v[64:67], 0
    ds_read_b64_tr_b16 v[132:133], v15 offset:33920
    ds_read_b64_tr_b16 v[134:135], v15 offset:50816
    s_waitcnt lgkmcnt(13)
    v_mfma_f32_16x16x32_bf16 v[84:87], v[148:151], v[68:71], v[84:87]
    ds_read_b64_tr_b16 v[136:137], v16 offset:128
    ds_read_b64_tr_b16 v[138:139], v16 offset:17024
    s_waitcnt lgkmcnt(13)
    v_mfma_f32_16x16x32_bf16 v[84:87], v[152:155], v[72:75], v[84:87]
    ds_read_b64_tr_b16 v[140:141], v16 offset:33920
    ds_read_b64_tr_b16 v[142:143], v16 offset:50816
    s_waitcnt lgkmcnt(13)
    v_mfma_f32_16x16x32_bf16 v[84:87], v[156:159], v[76:79], v[84:87]
    ds_read_b64_tr_b16 v[144:145], v15 offset:160
    ds_read_b64_tr_b16 v[146:147], v15 offset:17056
    s_waitcnt lgkmcnt(13)
    v_mfma_f32_16x16x32_bf16 v[88:91], v[160:163], v[64:67], 0
    ds_read_b64_tr_b16 v[148:149], v15 offset:33952
    ds_read_b64_tr_b16 v[150:151], v15 offset:50848
    s_waitcnt lgkmcnt(13)
    v_mfma_f32_16x16x32_bf16 v[88:91], v[164:167], v[68:71], v[88:91]
    ds_read_b64_tr_b16 v[152:153], v16 offset:160
    ds_read_b64_tr_b16 v[154:155], v16 offset:17056
    s_waitcnt lgkmcnt(13)
    v_mfma_f32_16x16x32_bf16 v[88:91], v[168:171], v[72:75], v[88:91]
    ds_read_b64_tr_b16 v[156:157], v16 offset:33952
    ds_read_b64_tr_b16 v[158:159], v16 offset:50848
    s_waitcnt lgkmcnt(13)
    v_mfma_f32_16x16x32_bf16 v[88:91], v[172:175], v[76:79], v[88:91]
    ds_read_b64_tr_b16 v[160:161], v15 offset:192
    ds_read_b64_tr_b16 v[162:163], v15 offset:17088
    v_cvt_pk_bf16_f32 v112, v80, v81
    v_cvt_pk_bf16_f32 v113, v82, v83
    v_cvt_pk_bf16_f32 v114, v84, v85
    v_cvt_pk_bf16_f32 v115, v86, v87
    s_nop 0
    v_permlane16_swap_b32 v112, v114
    v_permlane16_swap_b32 v113, v115
    buffer_store_dwordx4 v[112:115], v21, s[52:55], 0 offen offset:0 sc1
    v_add3_u32 v52, v112, v113, v114
    v_add_u32 v52, v52, v115
    s_waitcnt lgkmcnt(13)
    v_mfma_f32_16x16x32_bf16 v[92:95], v[176:179], v[64:67], 0
    ds_read_b64_tr_b16 v[164:165], v15 offset:33984
    ds_read_b64_tr_b16 v[166:167], v15 offset:50880
    s_waitcnt lgkmcnt(13)
    v_mfma_f32_16x16x32_bf16 v[92:95], v[180:183], v[68:71], v[92:95]
    ds_read_b64_tr_b16 v[168:169], v16 offset:192
    ds_read_b64_tr_b16 v[170:171], v16 offset:17088
    s_waitcnt lgkmcnt(13)
    v_mfma_f32_16x16x32_bf16 v[92:95], v[184:187], v[72:75], v[92:95]
    ds_read_b64_tr_b16 v[172:173], v16 offset:33984
    ds_read_b64_tr_b16 v[174:175], v16 offset:50880
    s_waitcnt lgkmcnt(13)
    v_mfma_f32_16x16x32_bf16 v[92:95], v[188:191], v[76:79], v[92:95]
    ds_read_b64_tr_b16 v[176:177], v15 offset:224
    ds_read_b64_tr_b16 v[178:179], v15 offset:17120
    s_waitcnt lgkmcnt(13)
    v_mfma_f32_16x16x32_bf16 v[96:99], v[128:131], v[64:67], 0
    ds_read_b64_tr_b16 v[180:181], v15 offset:34016
    ds_read_b64_tr_b16 v[182:183], v15 offset:50912
    s_waitcnt lgkmcnt(13)
    v_mfma_f32_16x16x32_bf16 v[96:99], v[132:135], v[68:71], v[96:99]
    ds_read_b64_tr_b16 v[184:185], v16 offset:224
    ds_read_b64_tr_b16 v[186:187], v16 offset:17120
    s_waitcnt lgkmcnt(13)
    v_mfma_f32_16x16x32_bf16 v[96:99], v[136:139], v[72:75], v[96:99]
    ds_read_b64_tr_b16 v[188:189], v16 offset:34016
    ds_read_b64_tr_b16 v[190:191], v16 offset:50912
    v_mfma_f32_16x16x32_bf16 v[96:99], v[140:143], v[76:79], v[96:99]
    v_cvt_pk_bf16_f32 v116, v88, v89
    v_cvt_pk_bf16_f32 v117, v90, v91
    v_cvt_pk_bf16_f32 v118, v92, v93
    v_cvt_pk_bf16_f32 v119, v94, v95
    s_nop 0
    v_permlane16_swap_b32 v116, v118
    v_permlane16_swap_b32 v117, v119
    buffer_store_dwordx4 v[116:119], v21, s[52:55], 0 offen offset:64 sc1
    v_add3_u32 v52, v52, v116, v117
    v_add3_u32 v52, v52, v118, v119
    v_mfma_f32_16x16x32_bf16 v[100:103], v[144:147], v[64:67], 0
    v_mfma_f32_16x16x32_bf16 v[100:103], v[148:151], v[68:71], v[100:103]
    v_mfma_f32_16x16x32_bf16 v[100:103], v[152:155], v[72:75], v[100:103]
    v_mfma_f32_16x16x32_bf16 v[100:103], v[156:159], v[76:79], v[100:103]
    s_waitcnt lgkmcnt(14)
    v_mfma_f32_16x16x32_bf16 v[104:107], v[160:163], v[64:67], 0
    s_waitcnt lgkmcnt(12)
    v_mfma_f32_16x16x32_bf16 v[104:107], v[164:167], v[68:71], v[104:107]
    s_waitcnt lgkmcnt(10)
    v_mfma_f32_16x16x32_bf16 v[104:107], v[168:171], v[72:75], v[104:107]
    s_waitcnt lgkmcnt(8)
    v_mfma_f32_16x16x32_bf16 v[104:107], v[172:175], v[76:79], v[104:107]
    v_cvt_pk_bf16_f32 v120, v96, v97
    v_cvt_pk_bf16_f32 v121, v98, v99
    v_cvt_pk_bf16_f32 v122, v100, v101
    v_cvt_pk_bf16_f32 v123, v102, v103
    s_nop 0
    v_permlane16_swap_b32 v120, v122
    v_permlane16_swap_b32 v121, v123
    buffer_store_dwordx4 v[120:123], v22, s[52:55], 0 offen offset:0 sc1
    v_add3_u32 v53, v120, v121, v122
    v_add_u32 v53, v53, v123
    s_waitcnt lgkmcnt(6)
    v_mfma_f32_16x16x32_bf16 v[108:111], v[176:179], v[64:67], 0
    s_waitcnt lgkmcnt(4)
    v_mfma_f32_16x16x32_bf16 v[108:111], v[180:183], v[68:71], v[108:111]
    s_waitcnt lgkmcnt(2)
    v_mfma_f32_16x16x32_bf16 v[108:111], v[184:187], v[72:75], v[108:111]
    s_waitcnt lgkmcnt(0)
    v_mfma_f32_16x16x32_bf16 v[108:111], v[188:191], v[76:79], v[108:111]
    v_cvt_pk_bf16_f32 v124, v104, v105
    v_cvt_pk_bf16_f32 v125, v106, v107
    s_nop 5
    v_cvt_pk_bf16_f32 v126, v108, v109
    v_cvt_pk_bf16_f32 v127, v110, v111
    s_nop 0
    v_permlane16_swap_b32 v124, v126
    v_permlane16_swap_b32 v125, v127
    buffer_store_dwordx4 v[124:127], v22, s[52:55], 0 offen offset:64 sc1
    v_add3_u32 v53, v53, v124, v125
    v_add3_u32 v53, v53, v126, v127
    v_mov_b32 v54, v52
    v_mov_b32 v55, v53
    s_nop 0
    v_permlane16_swap_b32 v52, v54
    v_permlane16_swap_b32 v53, v55
    v_add_u32 v52, v52, v54
    v_add_u32 v53, v53, v55
    v_mov_b32 v54, v52
    v_mov_b32 v55, v53
    s_nop 0
    v_permlane32_swap_b32 v52, v54
    v_permlane32_swap_b32 v53, v55
    v_add_u32 v52, v52, v54
    v_add_u32 v53, v53, v55
    v_cmp_eq_u32 vcc, 1, v2
    v_mov_b32 v60, v44
    v_mov_b32 v61, v47
    v_cndmask_b32 v62, v52, v53, vcc
    v_add3_u32 v63, v60, v61, v62
    v_add_u32 v63, s64, v63
    s_mov_b64 s[74:75], exec
    s_mov_b32 exec_hi, 0
    buffer_store_dwordx4 v[60:63], v23, s[52:55], 0 offen sc1
    s_mov_b64 exec, s[74:75]
    v_mov_b32 v52, 1
    s_mov_b64 s[74:75], exec
    s_mov_b64 exec, 1
    ds_add_u32 v3, v52 offset:20
    s_mov_b64 exec, s[74:75]
    s_lshl_b32 s66, s61, 3
    s_add_u32 s66, s66, s60
    s_lshl_b32 s66, s66, 2
    s_add_u32 s66, s66, s56
    s_lshl_b32 s66, s66, 5
    s_lshl_b32 s67, s66, 7
    s_add_u32 s67, s67, 0x200000
    v_lshl_add_u32 v40, v0, 4, s67
    s_lshl_b32 s67, s66, 4
    s_add_u32 s67, s67, 0x140000
    v_and_b32 v41, 31, v0
    v_lshl_add_u32 v41, v41, 4, s67
    v_cmp_gt_u32 s[76:77], 32, v0
    s_lshl_b32 s67, s56, 7
    s_add_u32 s67, s67, 158208
    v_lshl_add_u32 v43, v0, 4, s67
    v_bfe_u32 v42, v1, 2, 1
    v_lshl_add_u32 v42, v2, 1, v42
    v_lshlrev_b32 v42, 2, v42
    s_waitcnt vmcnt(0)
    v_mov_b32 v47, 1
    s_mov_b64 s[74:75], exec
    s_mov_b64 exec, 1
    ds_add_u32 v3, v47 offset:32
    s_mov_b64 exec, s[74:75]
    s_mov_b32 s73, 0
L_fw_19:
    ds_read_b32 v47, v3 offset:32
    s_waitcnt lgkmcnt(0)
    v_cmp_gt_u32 vcc, 4, v47
    s_cbranch_vccz L_fd_20
    s_add_u32 s73, s73, 1
    s_cmp_lt_u32 s73, 2000000
    s_cbranch_scc1 L_fw_19
L_fd_20:
    s_mov_b32 s72, 0
L_hop3_21:
    buffer_load_dwordx4 v[128:131], v40, s[52:55], 0 offen offset:0 sc1
    buffer_load_dwordx4 v[132:135], v40, s[52:55], 0 offen offset:1024 sc1
    buffer_load_dwordx4 v[136:139], v40, s[52:55], 0 offen offset:2048 sc1
    buffer_load_dwordx4 v[140:143], v40, s[52:55], 0 offen offset:3072 sc1
    buffer_load_dwordx4 v[144:147], v41, s[52:55], 0 offen sc1
    s_waitcnt vmcnt(0)
    v_add3_u32 v45, v144, v145, v146
    v_add_u32 v45, s64, v45
    v_cmp_ne_u32 s[78:79], v45, v147
    v_add3_u32 v44, v128, v129, v130
    v_add3_u32 v44, v44, v131, v132
    v_add3_u32 v44, v44, v133, v134
    v_add3_u32 v44, v44, v135, v136
    v_add3_u32 v44, v44, v137, v138
    v_add3_u32 v44, v44, v139, v140
    v_add3_u32 v44, v44, v141, v142
    v_add_u32 v44, v44, v143
    v_cndmask_b32 v45, 0, v146, s[76:77]
    v_sub_u32 v44, v44, v45
    v_mov_b32 v54, v144
    s_nop 0
    v_add_u32_dpp v44, v44, v44 quad_perm:[1,0,3,2] row_mask:0xf bank_mask:0xf
    v_max_f32_dpp v54, v54, v54 quad_perm:[1,0,3,2] row_mask:0xf bank_mask:0xf
    s_nop 0
    v_add_u32_dpp v44, v44, v44 quad_perm:[2,3,0,1] row_mask:0xf bank_mask:0xf
    v_max_f32_dpp v54, v54, v54 quad_perm:[2,3,0,1] row_mask:0xf bank_mask:0xf
    s_nop 0
    v_add_u32_dpp v44, v44, v44 row_half_mirror row_mask:0xf bank_mask:0xf
    v_max_f32_dpp v54, v54, v54 row_half_mirror row_mask:0xf bank_mask:0xf
    s_nop 0
    v_add_u32_dpp v44, v44, v44 row_mirror row_mask:0xf bank_mask:0xf
    v_max_f32_dpp v54, v54, v54 row_mirror row_mask:0xf bank_mask:0xf
    v_mov_b32 v46, v44
    v_mov_b32 v55, v54
    s_nop 0
    v_permlane16_swap_b32 v44, v46
    v_permlane16_swap_b32 v54, v55
    v_add_u32 v44, v44, v46
    v_max_f32 v54, v54, v55
    v_mov_b32 v46, v44
    v_sub_f32 v54, v144, v54
    v_exp_f32 v54, v54
    v_permlane32_swap_b32 v44, v46
    ds_bpermute_b32 v48, v42, v54 offset:0
    ds_bpermute_b32 v49, v42, v54 offset:32
    ds_bpermute_b32 v50, v42, v54 offset:64
    ds_bpermute_b32 v51, v42, v54 offset:96
    v_add_u32 v44, v44, v46
    v_cmp_ne_u32 vcc, 0, v44
    s_or_b64 s[78:79], s[78:79], vcc
    s_cmp_eq_u64 s[78:79], 0
    s_cbranch_scc1 done_22
    s_add_u32 s72, s72, 1
    s_cmp_lt_u32 s72, 20000
    s_cbranch_scc1 L_hop3_21
done_22:
    v_mul_f32 v45, v54, v145
    v_swap_b32 v130, v132
    v_swap_b32 v131, v133
    v_swap_b32 v138, v140
    v_swap_b32 v139, v141
    v_add_f32_dpp v45, v45, v45 quad_perm:[1,0,3,2] row_mask:0xf bank_mask:0xf
    s_waitcnt lgkmcnt(0)
    v_cvt_pk_bf16_f32 v52, v48, v49
    v_cvt_pk_bf16_f32 v53, v50, v51
    v_add_f32_dpp v45, v45, v45 quad_perm:[2,3,0,1] row_mask:0xf bank_mask:0xf
    v_perm_b32 v24, v52, v52, v4
    v_perm_b32 v25, v52, v52, v5
    v_perm_b32 v26, v52, v52, v6
    v_perm_b32 v27, v52, v52, v7
    v_add_f32_dpp v45, v45, v45 row_half_mirror row_mask:0xf bank_mask:0xf
    v_perm_b32 v28, v53, v53, v4
    v_perm_b32 v29, v53, v53, v5
    v_perm_b32 v30, v53, v53, v6
    v_perm_b32 v31, v53, v53, v7
    v_add_f32_dpp v45, v45, v45 row_mirror row_mask:0xf bank_mask:0xf
    v_mfma_f32_16x16x32_bf16 v[32:35], v[24:27], v[128:131], 0
    v_mfma_f32_16x16x32_bf16 v[36:39], v[24:27], v[132:135], 0
    v_mov_b32 v46, v45
    v_mfma_f32_16x16x32_bf16 v[32:35], v[28:31], v[136:139], v[32:35]
    v_mfma_f32_16x16x32_bf16 v[36:39], v[28:31], v[140:143], v[36:39]
    v_permlane16_swap_b32 v45, v46
    v_add_f32 v45, v45, v46
    v_rcp_f32 v45, v45
    v_mov_b32 v47, 1
    s_mov_b64 s[74:75], exec
    s_mov_b64 exec, 1
    ds_add_u32 v3, v47 offset:24
    s_mov_b64 exec, s[74:75]
    v_permlane16_swap_b32 v32, v56
    v_permlane16_swap_b32 v33, v57
    v_permlane16_swap_b32 v34, v58
    v_permlane16_swap_b32 v35, v59
    v_permlane16_swap_b32 v36, v60
    v_permlane16_swap_b32 v37, v61
    v_permlane16_swap_b32 v38, v62
    v_permlane16_swap_b32 v39, v63
    v_add_f32_dpp v56, v56, v32 row_ror:8 row_mask:0xf bank_mask:0xf
    v_add_f32_dpp v57, v57, v33 row_ror:8 row_mask:0xf bank_mask:0xf
    v_add_f32_dpp v58, v58, v34 row_ror:8 row_mask:0xf bank_mask:0xf
    v_add_f32_dpp v59, v59, v35 row_ror:8 row_mask:0xf bank_mask:0xf
    v_add_f32_dpp v60, v60, v36 row_ror:8 row_mask:0xf bank_mask:0xf
    v_add_f32_dpp v61, v61, v37 row_ror:8 row_mask:0xf bank_mask:0xf
    v_add_f32_dpp v62, v62, v38 row_ror:8 row_mask:0xf bank_mask:0xf
    v_add_f32_dpp v63, v63, v39 row_ror:8 row_mask:0xf bank_mask:0xf
    v_mul_f32 v56, v56, v45
    v_mul_f32 v57, v57, v45
    v_mul_f32 v58, v58, v45
    v_mul_f32 v59, v59, v45
    v_mul_f32 v60, v60, v45
    v_mul_f32 v61, v61, v45
    v_mul_f32 v62, v62, v45
    v_mul_f32 v63, v63, v45
    v_cvt_pk_bf16_f32 v48, v56, v57
    v_cvt_pk_bf16_f32 v49, v58, v59
    v_cvt_pk_bf16_f32 v50, v60, v61
    v_cvt_pk_bf16_f32 v51, v62, v63
    s_mov_b64 exec, 0xff
    ds_write_b128 v43, v[48:51]
    s_mov_b64 exec, -1
    s_cmp_ge_u32 s2, 64
    s_cbranch_scc1 L_Mdone
    s_cmp_lg_u32 s56, 0
    s_cbranch_scc1 L_Mdone
    s_mul_i32 s66, s2, 48
    s_lshl_b32 s68, s66, 6
    s_add_u32 s68, s68, 0xe0000
    v_lshl_add_u32 v40, v0, 4, s68
    s_lshl_b32 s68, s66, 3
    s_add_u32 s68, s68, 0x130000
    v_lshl_add_u32 v41, v0, 3, s68
    v_mov_b32 v47, 0x7ffffff0
    v_lshrrev_b32 v44, 2, v0
    v_add_u32 v44, 32, v44
    v_cmp_gt_u32 vcc, 43, v44
    v_add_u32 v46, 2048, v40
    s_nop 0
    v_cndmask_b32 v42, v47, v46, vcc
    v_cmp_gt_u32 s[4:5], 43, v0
    s_nop 1
    v_cndmask_b32 v41, v47, v41, s[4:5]
    v_and_b32 v44, 3, v1
    v_mov_b32 v45, 0
    v_mov_b32 v46, 0x3f80
    v_cmp_eq_u32 vcc, 0, v44
    s_nop 1
    v_cndmask_b32 v24, v45, v46, vcc
    v_mov_b32 v46, 0x3f800000
    v_cmp_eq_u32 vcc, 1, v44
    s_nop 1
    v_cndmask_b32 v24, v24, v46, vcc
    v_mov_b32 v46, 0x3f80
    v_cmp_eq_u32 vcc, 2, v44
    s_nop 1
    v_cndmask_b32 v25, v45, v46, vcc
    v_mov_b32 v46, 0x3f800000
    v_cmp_eq_u32 vcc, 3, v44
    s_nop 1
    v_cndmask_b32 v25, v25, v46, vcc
    v_mov_b32 v26, v24
    v_mov_b32 v27, v25
    v_mov_b32 v140, 0
    v_mov_b32 v141, 0
    v_mov_b32 v142, 0
    v_mov_b32 v143, 0
    s_lshl_b32 s69, s2, 6
    v_lshl_add_u32 v57, v0, 4, s69
    s_mov_b32 s73, 0
L_fw_23:
    ds_read_b32 v44, v3 offset:16
    s_waitcnt lgkmcnt(0)
    v_cmp_gt_u32 vcc, 1, v44
    s_cbranch_vccz L_fd_24
    s_add_u32 s73, s73, 1
    s_cmp_lt_u32 s73, 2000000
    s_cbranch_scc1 L_fw_23
L_fd_24:
    s_mov_b32 s72, 0
L_hop5_25:
    buffer_load_dwordx4 v[128:131], v40, s[52:55], 0 offen offset:0 sc1
    buffer_load_dwordx4 v[132:135], v40, s[52:55], 0 offen offset:1024 sc1
    buffer_load_dwordx4 v[136:139], v42, s[52:55], 0 offen sc1
    buffer_load_dwordx2 v[152:153], v41, s[52:55], 0 offen sc1
    s_waitcnt vmcnt(0)
    v_add_u32 v45, s64, v152
    v_cmp_ne_u32 vcc, v45, v153
    s_and_b64 s[78:79], vcc, s[4:5]
    v_add3_u32 v44, v128, v129, v130
    v_add3_u32 v44, v44, v131, v132
    v_add3_u32 v44, v44, v133, v134
    v_add3_u32 v44, v44, v135, v136
    v_add3_u32 v44, v44, v137, v138
    v_add_u32 v44, v44, v139
    v_sub_u32 v44, v44, v152
    s_nop 1
    v_add_u32_dpp v44, v44, v44 quad_perm:[1,0,3,2] row_mask:0xf bank_mask:0xf
    v_swap_b32 v130, v132
    v_swap_b32 v131, v133
    v_add_u32_dpp v44, v44, v44 quad_perm:[2,3,0,1] row_mask:0xf bank_mask:0xf
    v_swap_b32 v138, v140
    v_swap_b32 v139, v141
    v_add_u32_dpp v44, v44, v44 row_half_mirror row_mask:0xf bank_mask:0xf
    v_mfma_f32_16x16x32_bf16 v[32:35], v[24:27], v[128:131], 0
    v_mfma_f32_16x16x32_bf16 v[36:39], v[24:27], v[132:135], 0
    v_add_u32_dpp v44, v44, v44 row_mirror row_mask:0xf bank_mask:0xf
    v_mov_b32 v46, v44
    v_mfma_f32_16x16x32_bf16 v[32:35], v[24:27], v[136:139], v[32:35]
    v_mfma_f32_16x16x32_bf16 v[36:39], v[24:27], v[140:143], v[36:39]
    v_permlane16_swap_b32 v44, v46
    v_add_u32 v44, v44, v46
    v_mov_b32 v46, v44
    s_nop 1
    v_permlane32_swap_b32 v44, v46
    v_add_u32 v44, v44, v46
    v_mov_b32 v140, 0
    v_mov_b32 v141, 0
    v_mov_b32 v142, 0
    v_mov_b32 v143, 0
    v_cmp_ne_u32 vcc, 0, v44
    s_or_b64 s[78:79], s[78:79], vcc
    s_cmp_eq_u64 s[78:79], 0
    s_cbranch_scc1 done_26
    s_add_u32 s72, s72, 1
    s_cmp_lt_u32 s72, 20000
    s_cbranch_scc1 L_hop5_25
done_26:
    v_add_f32_dpp v32, v32, v32 row_ror:4 row_mask:0xf bank_mask:0xf
    v_add_f32_dpp v33, v33, v33 row_ror:4 row_mask:0xf bank_mask:0xf
    v_add_f32_dpp v34, v34, v34 row_ror:4 row_mask:0xf bank_mask:0xf
    v_add_f32_dpp v35, v35, v35 row_ror:4 row_mask:0xf bank_mask:0xf
    v_add_f32_dpp v36, v36, v36 row_ror:4 row_mask:0xf bank_mask:0xf
    v_add_f32_dpp v37, v37, v37 row_ror:4 row_mask:0xf bank_mask:0xf
    v_add_f32_dpp v38, v38, v38 row_ror:4 row_mask:0xf bank_mask:0xf
    v_add_f32_dpp v39, v39, v39 row_ror:4 row_mask:0xf bank_mask:0xf
    v_add_f32_dpp v32, v32, v32 row_ror:8 row_mask:0xf bank_mask:0xf
    v_add_f32_dpp v33, v33, v33 row_ror:8 row_mask:0xf bank_mask:0xf
    v_add_f32_dpp v34, v34, v34 row_ror:8 row_mask:0xf bank_mask:0xf
    v_add_f32_dpp v35, v35, v35 row_ror:8 row_mask:0xf bank_mask:0xf
    v_add_f32_dpp v36, v36, v36 row_ror:8 row_mask:0xf bank_mask:0xf
    v_add_f32_dpp v37, v37, v37 row_ror:8 row_mask:0xf bank_mask:0xf
    v_add_f32_dpp v38, v38, v38 row_ror:8 row_mask:0xf bank_mask:0xf
    v_add_f32_dpp v39, v39, v39 row_ror:8 row_mask:0xf bank_mask:0xf
    v_cvt_pk_bf16_f32 v48, v32, v33
    v_cvt_pk_bf16_f32 v49, v34, v35
    v_cvt_pk_bf16_f32 v50, v36, v37
    v_cvt_pk_bf16_f32 v51, v38, v39
    s_mov_b64 exec, 0xf
    buffer_store_dwordx4 v[48:51], v57, s[48:51], 0 offen
    s_cmp_lg_u32 s2, 0
    s_cbranch_scc1 L_Mdone
    s_add_u32 s66, s65, 1
    v_mov_b32 v52, s66
    v_mov_b32 v53, 0x0
    s_mov_b64 exec, 1
    buffer_store_dword v52, v53, s[52:55], 0 offen sc1
L_Mdone:
    s_endpgm
L_Lpath:
    s_sub_u32 s56, s56, 4
    v_lshlrev_b32 v40, 4, v0
    v_mov_b32 v43, 0x0
    s_cmp_lg_u32 s56, 3
    s_cbranch_scc1 L_nopf
    s_getpc_b64 s[66:67]
L_pcref:
    s_sub_u32 s66, s66, (L_pcref-gated_mix__compressed_kv_cla__dense_activation_mish__decode_kernel)
    s_subb_u32 s67, s67, 0
    s_lshl_b32 s68, s58, 10
    v_lshl_add_u32 v44, v0, 7, s68
    v_cmp_gt_u32 vcc, (L_end-gated_mix__compressed_kv_cla__dense_activation_mish__decode_kernel), v44
    v_cmp_gt_u32 s[6:7], 8, v0
    s_and_b64 vcc, vcc, s[6:7]
    s_and_saveexec_b64 s[74:75], vcc
    s_cbranch_execz L_pfskip
    global_load_dword v63, v44, s[66:67]
L_pfskip:
    s_mov_b64 exec, s[74:75]
L_nopf:
    s_lshl_b32 s66, s62, 12
    s_lshl_b32 s67, s63, 7
    s_add_u32 s66, s66, s67
    s_lshl_b32 s67, s56, 5
    s_add_u32 s66, s66, s67
    s_lshl_b32 s66, s66, 10
    s_mul_i32 s67, s56, 33792
    s_mov_b32 m0, s67
    s_mov_b32 s72, 0
    s_mov_b32 s73, 0
L_fw_27:
    ds_read_b32 v45, v3 offset:40
    s_waitcnt lgkmcnt(0)
    v_cmp_gt_u32 vcc, 1, v45
    s_cbranch_vccz L_fd_28
    s_add_u32 s73, s73, 1
    s_cmp_lt_u32 s73, 2000000
    s_cbranch_scc1 L_fw_27
L_fd_28:
L_dma:
    s_waitcnt vmcnt(6)
    buffer_load_dwordx4 v40, s[12:15], s66 offen nt lds
    s_add_u32 m0, m0, 1056
    s_add_u32 s66, s66, 1024
    s_add_u32 s72, s72, 1
    s_cmp_lt_u32 s72, 32
    s_cbranch_scc1 L_dma
    v_mov_b32 v45, 1
    s_mov_b64 s[74:75], exec
    s_mov_b64 exec, 1
    ds_add_u32 v3, v45 offset:0
    s_mov_b64 exec, s[74:75]
    v_and_b32 v44, 3, v1
    v_mov_b32 v45, 0x0c0c0c0c
    v_mov_b32 v46, 0xc0c0100
    v_cmp_eq_u32 vcc, 0, v44
    s_nop 1
    v_cndmask_b32 v4, v45, v46, vcc
    v_mov_b32 v46, 0x1000c0c
    v_cmp_eq_u32 vcc, 1, v44
    s_nop 1
    v_cndmask_b32 v4, v4, v46, vcc
    v_mov_b32 v46, 0xc0c0100
    v_cmp_eq_u32 vcc, 2, v44
    s_nop 1
    v_cndmask_b32 v5, v45, v46, vcc
    v_mov_b32 v46, 0x1000c0c
    v_cmp_eq_u32 vcc, 3, v44
    s_nop 1
    v_cndmask_b32 v5, v5, v46, vcc
    v_mov_b32 v46, 0xc0c0302
    v_cmp_eq_u32 vcc, 0, v44
    s_nop 1
    v_cndmask_b32 v6, v45, v46, vcc
    v_mov_b32 v46, 0x3020c0c
    v_cmp_eq_u32 vcc, 1, v44
    s_nop 1
    v_cndmask_b32 v6, v6, v46, vcc
    v_mov_b32 v46, 0xc0c0302
    v_cmp_eq_u32 vcc, 2, v44
    s_nop 1
    v_cndmask_b32 v7, v45, v46, vcc
    v_mov_b32 v46, 0x3020c0c
    v_cmp_eq_u32 vcc, 3, v44
    s_nop 1
    v_cndmask_b32 v7, v7, v46, vcc
    s_waitcnt vmcnt(0)
    v_mov_b32 v45, 1
    s_mov_b64 s[74:75], exec
    s_mov_b64 exec, 1
    ds_add_u32 v3, v45 offset:4
    s_mov_b64 exec, s[74:75]
    s_cmp_eq_u32 s56, 0
    s_cbranch_scc1 L_tail
    s_cmp_lg_u32 s56, 1
    s_cbranch_scc1 L_mlpw
L_gate:
    buffer_load_dwordx4 v[64:67], v40, s[8:11], 0 offen offset:0
    buffer_load_dwordx4 v[68:71], v40, s[8:11], 0 offen offset:1024
    buffer_load_dwordx4 v[72:75], v40, s[8:11], 0 offen offset:2048
    buffer_load_dwordx4 v[76:79], v40, s[8:11], 0 offen offset:3072
    buffer_load_dwordx4 v[80:83], v40, s[44:47], 0 offen
    v_mov_b32 v44, 0
    v_mov_b32 v45, 0
    v_mov_b32 v46, 0
    v_mov_b32 v47, 0
    s_waitcnt vmcnt(0)
    v_dot2_f32_bf16 v44, v64, v80, v44
    v_dot2_f32_bf16 v45, v68, v80, v45
    v_dot2_f32_bf16 v46, v72, v80, v46
    v_dot2_f32_bf16 v47, v76, v80, v47
    v_dot2_f32_bf16 v44, v65, v81, v44
    v_dot2_f32_bf16 v45, v69, v81, v45
    v_dot2_f32_bf16 v46, v73, v81, v46
    v_dot2_f32_bf16 v47, v77, v81, v47
    v_dot2_f32_bf16 v44, v66, v82, v44
    v_dot2_f32_bf16 v45, v70, v82, v45
    v_dot2_f32_bf16 v46, v74, v82, v46
    v_dot2_f32_bf16 v47, v78, v82, v47
    v_dot2_f32_bf16 v44, v67, v83, v44
    v_dot2_f32_bf16 v45, v71, v83, v45
    v_dot2_f32_bf16 v46, v75, v83, v46
    v_dot2_f32_bf16 v47, v79, v83, v47
    s_nop 3
    v_add_f32_dpp v44, v44, v44 quad_perm:[1,0,3,2] row_mask:0xf bank_mask:0xf
    v_add_f32_dpp v45, v45, v45 quad_perm:[1,0,3,2] row_mask:0xf bank_mask:0xf
    v_add_f32_dpp v46, v46, v46 quad_perm:[1,0,3,2] row_mask:0xf bank_mask:0xf
    v_add_f32_dpp v47, v47, v47 quad_perm:[1,0,3,2] row_mask:0xf bank_mask:0xf
    v_add_f32_dpp v44, v44, v44 quad_perm:[2,3,0,1] row_mask:0xf bank_mask:0xf
    v_add_f32_dpp v45, v45, v45 quad_perm:[2,3,0,1] row_mask:0xf bank_mask:0xf
    v_add_f32_dpp v46, v46, v46 quad_perm:[2,3,0,1] row_mask:0xf bank_mask:0xf
    v_add_f32_dpp v47, v47, v47 quad_perm:[2,3,0,1] row_mask:0xf bank_mask:0xf
    v_add_f32_dpp v44, v44, v44 row_half_mirror row_mask:0xf bank_mask:0xf
    v_add_f32_dpp v45, v45, v45 row_half_mirror row_mask:0xf bank_mask:0xf
    v_add_f32_dpp v46, v46, v46 row_half_mirror row_mask:0xf bank_mask:0xf
    v_add_f32_dpp v47, v47, v47 row_half_mirror row_mask:0xf bank_mask:0xf
    v_add_f32_dpp v44, v44, v44 row_mirror row_mask:0xf bank_mask:0xf
    v_add_f32_dpp v45, v45, v45 row_mirror row_mask:0xf bank_mask:0xf
    v_add_f32_dpp v46, v46, v46 row_mirror row_mask:0xf bank_mask:0xf
    v_add_f32_dpp v47, v47, v47 row_mirror row_mask:0xf bank_mask:0xf
    v_mov_b32 v48, v44
    v_mov_b32 v49, v45
    s_nop 0
    v_permlane16_swap_b32 v44, v48
    v_permlane16_swap_b32 v45, v49
    v_add_f32 v44, v44, v48
    v_add_f32 v45, v45, v49
    v_mov_b32 v48, v44
    v_mov_b32 v49, v45
    s_nop 0
    v_permlane32_swap_b32 v44, v48
    v_permlane32_swap_b32 v45, v49
    v_add_f32 v44, v44, v48
    v_add_f32 v45, v45, v49
    v_mov_b32 v48, v46
    v_mov_b32 v49, v47
    s_nop 0
    v_permlane16_swap_b32 v46, v48
    v_permlane16_swap_b32 v47, v49
    v_add_f32 v46, v46, v48
    v_add_f32 v47, v47, v49
    v_mov_b32 v48, v46
    v_mov_b32 v49, v47
    s_nop 0
    v_permlane32_swap_b32 v46, v48
    v_permlane32_swap_b32 v47, v49
    v_add_f32 v46, v46, v48
    v_add_f32 v47, v47, v49
    v_cmp_eq_u32 vcc, 1, v2
    s_nop 1
    v_cndmask_b32 v44, v44, v45, vcc
    v_cmp_eq_u32 vcc, 2, v2
    s_nop 1
    v_cndmask_b32 v44, v44, v46, vcc
    v_cmp_eq_u32 vcc, 3, v2
    s_nop 1
    v_cndmask_b32 v44, v44, v47, vcc
    s_mov_b32 s66, 0xbfb8aa3b
    v_mul_f32 v44, s66, v44
    v_exp_f32 v44, v44
    s_nop 0
    v_add_f32 v44, 1.0, v44
    v_rcp_f32 v58, v44
    v_lshlrev_b32 v45, 2, v2
    v_add_u32 v45, 153600, v45
    ds_write_b32 v45, v58
    v_mov_b32 v45, 1
    s_mov_b64 s[74:75], exec
    s_mov_b64 exec, 1
    ds_add_u32 v3, v45 offset:44
    s_mov_b64 exec, s[74:75]
    s_branch L_Ldone
L_mlpw:
    s_cmp_lg_u32 s56, 2
    s_cbranch_scc1 L_Ldone
    s_lshr_b32 s66, s58, 3
    s_lshl_b32 s66, s66, 3
    s_add_u32 s69, s66, s57
    s_cmp_ge_u32 s69, 11
    s_cbranch_scc1 L_Ldone
    s_and_b32 s70, s58, 7
    s_lshl_b32 s71, s69, 3
    s_add_u32 s71, s71, s70
    v_lshrrev_b32 v41, 2, v1
    v_lshlrev_b32 v41, 10, v41
    v_lshl_add_u32 v41, v2, 5, v41
    s_lshl_b32 s66, s70, 7
    v_add_u32 v41, s66, v41
    s_lshl_b32 s66, s70, 6
    v_lshl_add_u32 v42, v2, 4, s66
    s_movk_i32 s67, 2752
    v_mul_lo_u32 v42, v42, s67
    s_lshl_b32 s66, s69, 8
    v_lshl_add_u32 v44, v1, 4, s66
    v_add_u32 v42, v42, v44
    v_cmp_gt_u32 vcc, 2752, v44
    v_mov_b32 v45, 0x7ffffff0
    s_nop 0
    v_cndmask_b32 v42, v45, v42, vcc
    v_cndmask_b32 v44, v45, v44, vcc
    s_lshl_b32 s66, s69, 17
    s_lshl_b32 s67, s70, 7
    s_add_u32 s66, s66, s67
    v_lshlrev_b32 v46, 15, v2
    v_lshl_add_u32 v46, v1, 3, v46
    v_add_u32 v48, s66, v46
    s_mov_b32 s73, 0
L_fw_29:
    ds_read_b32 v46, v3 offset:20
    s_waitcnt lgkmcnt(0)
    v_cmp_gt_u32 vcc, 4, v46
    s_cbranch_vccz L_fd_30
    s_add_u32 s73, s73, 1
    s_cmp_lt_u32 s73, 2000000
    s_cbranch_scc1 L_fw_29
L_fd_30:
    buffer_load_dword v40, v43, s[52:55], 0 offen sc1
    buffer_load_dwordx4 v[8:11], v41, s[8:11], 0 offen offset:0
    buffer_load_dwordx4 v[12:15], v41, s[8:11], 0 offen offset:16
    buffer_load_dwordx4 v[60:63], v44, s[36:39], 0 offen
    s_mov_b32 s68, 0
    buffer_load_dwordx4 v[64:67], v42, s[32:35], s68 offen nt
    s_add_u32 s68, s68, 2752
    buffer_load_dwordx4 v[68:71], v42, s[32:35], s68 offen nt
    s_add_u32 s68, s68, 2752
    buffer_load_dwordx4 v[72:75], v42, s[32:35], s68 offen nt
    s_add_u32 s68, s68, 2752
    buffer_load_dwordx4 v[76:79], v42, s[32:35], s68 offen nt
    s_add_u32 s68, s68, 2752
    buffer_load_dwordx4 v[80:83], v42, s[32:35], s68 offen nt
    s_add_u32 s68, s68, 2752
    buffer_load_dwordx4 v[84:87], v42, s[32:35], s68 offen nt
    s_add_u32 s68, s68, 2752
    buffer_load_dwordx4 v[88:91], v42, s[32:35], s68 offen nt
    s_add_u32 s68, s68, 2752
    buffer_load_dwordx4 v[92:95], v42, s[32:35], s68 offen nt
    s_add_u32 s68, s68, 2752
    buffer_load_dwordx4 v[96:99], v42, s[32:35], s68 offen nt
    s_add_u32 s68, s68, 2752
    buffer_load_dwordx4 v[100:103], v42, s[32:35], s68 offen nt
    s_add_u32 s68, s68, 2752
    buffer_load_dwordx4 v[104:107], v42, s[32:35], s68 offen nt
    s_add_u32 s68, s68, 2752
    buffer_load_dwordx4 v[108:111], v42, s[32:35], s68 offen nt
    s_add_u32 s68, s68, 2752
    buffer_load_dwordx4 v[112:115], v42, s[32:35], s68 offen nt
    s_add_u32 s68, s68, 2752
    buffer_load_dwordx4 v[116:119], v42, s[32:35], s68 offen nt
    s_add_u32 s68, s68, 2752
    buffer_load_dwordx4 v[120:123], v42, s[32:35], s68 offen nt
    s_add_u32 s68, s68, 2752
    buffer_load_dwordx4 v[124:127], v42, s[32:35], s68 offen nt
    v_mov_b32 v43, v48
    s_mov_b32 s68, 0
    buffer_load_dwordx2 v[128:129], v43, s[40:43], s68 offen offset:0 nt
    buffer_load_dwordx2 v[130:131], v43, s[40:43], s68 offen offset:1024 nt
    buffer_load_dwordx2 v[132:133], v43, s[40:43], s68 offen offset:2048 nt
    buffer_load_dwordx2 v[134:135], v43, s[40:43], s68 offen offset:3072 nt
    s_add_u32 s68, s68, 4096
    buffer_load_dwordx2 v[136:137], v43, s[40:43], s68 offen offset:0 nt
    buffer_load_dwordx2 v[138:139], v43, s[40:43], s68 offen offset:1024 nt
    buffer_load_dwordx2 v[140:141], v43, s[40:43], s68 offen offset:2048 nt
    buffer_load_dwordx2 v[142:143], v43, s[40:43], s68 offen offset:3072 nt
    s_add_u32 s68, s68, 4096
    buffer_load_dwordx2 v[144:145], v43, s[40:43], s68 offen offset:0 nt
    buffer_load_dwordx2 v[146:147], v43, s[40:43], s68 offen offset:1024 nt
    buffer_load_dwordx2 v[148:149], v43, s[40:43], s68 offen offset:2048 nt
    buffer_load_dwordx2 v[150:151], v43, s[40:43], s68 offen offset:3072 nt
    s_add_u32 s68, s68, 4096
    buffer_load_dwordx2 v[152:153], v43, s[40:43], s68 offen offset:0 nt
    buffer_load_dwordx2 v[154:155], v43, s[40:43], s68 offen offset:1024 nt
    buffer_load_dwordx2 v[156:157], v43, s[40:43], s68 offen offset:2048 nt
    buffer_load_dwordx2 v[158:159], v43, s[40:43], s68 offen offset:3072 nt
    s_add_u32 s68, s68, 4096
    buffer_load_dwordx2 v[160:161], v43, s[40:43], s68 offen offset:0 nt
    buffer_load_dwordx2 v[162:163], v43, s[40:43], s68 offen offset:1024 nt
    buffer_load_dwordx2 v[164:165], v43, s[40:43], s68 offen offset:2048 nt
    buffer_load_dwordx2 v[166:167], v43, s[40:43], s68 offen offset:3072 nt
    s_add_u32 s68, s68, 4096
    buffer_load_dwordx2 v[168:169], v43, s[40:43], s68 offen offset:0 nt
    buffer_load_dwordx2 v[170:171], v43, s[40:43], s68 offen offset:1024 nt
    buffer_load_dwordx2 v[172:173], v43, s[40:43], s68 offen offset:2048 nt
    buffer_load_dwordx2 v[174:175], v43, s[40:43], s68 offen offset:3072 nt
    s_add_u32 s68, s68, 4096
    buffer_load_dwordx2 v[176:177], v43, s[40:43], s68 offen offset:0 nt
    buffer_load_dwordx2 v[178:179], v43, s[40:43], s68 offen offset:1024 nt
    buffer_load_dwordx2 v[180:181], v43, s[40:43], s68 offen offset:2048 nt
    buffer_load_dwordx2 v[182:183], v43, s[40:43], s68 offen offset:3072 nt
    s_add_u32 s68, s68, 4096
    buffer_load_dwordx2 v[184:185], v43, s[40:43], s68 offen offset:0 nt
    buffer_load_dwordx2 v[186:187], v43, s[40:43], s68 offen offset:1024 nt
    buffer_load_dwordx2 v[188:189], v43, s[40:43], s68 offen offset:2048 nt
    buffer_load_dwordx2 v[190:191], v43, s[40:43], s68 offen offset:3072 nt
    v_and_b32 v46, 3, v1
    v_lshrrev_b32 v47, 2, v1
    v_mov_b32 v48, 0
    v_mov_b32 v49, 0x3f80
    v_cmp_eq_u32 vcc, 0, v46
    s_nop 1
    v_cndmask_b32 v50, v48, v49, vcc
    v_mov_b32 v49, 0x3f800000
    v_cmp_eq_u32 vcc, 1, v46
    s_nop 1
    v_cndmask_b32 v50, v50, v49, vcc
    v_mov_b32 v49, 0x3f80
    v_cmp_eq_u32 vcc, 2, v46
    s_nop 1
    v_cndmask_b32 v51, v48, v49, vcc
    v_mov_b32 v49, 0x3f800000
    v_cmp_eq_u32 vcc, 3, v46
    s_nop 1
    v_cndmask_b32 v51, v51, v49, vcc
    v_cmp_eq_u32 vcc, 0, v47
    s_nop 1
    v_cndmask_b32 v192, v48, v50, vcc
    v_cndmask_b32 v193, v48, v51, vcc
    v_mov_b32 v194, v192
    v_mov_b32 v195, v193
    v_cmp_eq_u32 vcc, 1, v47
    s_nop 1
    v_cndmask_b32 v196, v48, v50, vcc
    v_cndmask_b32 v197, v48, v51, vcc
    v_mov_b32 v198, v196
    v_mov_b32 v199, v197
    v_cmp_eq_u32 vcc, 2, v47
    s_nop 1
    v_cndmask_b32 v200, v48, v50, vcc
    v_cndmask_b32 v201, v48, v51, vcc
    v_mov_b32 v202, v200
    v_mov_b32 v203, v201
    v_cmp_eq_u32 vcc, 3, v47
    s_nop 1
    v_cndmask_b32 v204, v48, v50, vcc
    v_cndmask_b32 v205, v48, v51, vcc
    v_mov_b32 v206, v204
    v_mov_b32 v207, v205
    s_lshl_b32 s66, s71, 10
    s_add_u32 s66, s66, 0x1c0000
    v_lshl_add_u32 v52, v0, 4, s66
    s_lshl_b32 s66, s71, 3
    s_add_u32 s66, s66, 0x1e0000
    v_mov_b32 v53, s66
    s_lshl_b32 s66, s69, 13
    s_add_u32 s66, s66, 0x1c0000
    v_lshlrev_b32 v46, 10, v2
    v_lshl_add_u32 v46, v1, 4, v46
    v_add_u32 v54, s66, v46
    v_add_u32 v55, 4096, v54
    s_lshl_b32 s66, s69, 6
    s_add_u32 s66, s66, 0x1e0000
    v_lshl_add_u32 v46, v0, 3, s66
    v_cmp_gt_u32 s[4:5], 8, v0
    v_mov_b32 v47, 0x7ffffff0
    s_nop 0
    v_cndmask_b32 v56, v47, v46, s[4:5]
    v_lshrrev_b32 v46, 3, v1
    v_lshl_add_u32 v46, v2, 4, v46
    s_lshl_b32 s66, s70, 1
    v_add_u32 v46, s66, v46
    s_movk_i32 s67, 48
    v_mul_lo_u32 v46, v46, s67
    s_add_u32 s66, s69, 32
    v_add_u32 v46, s66, v46
    v_lshlrev_b32 v58, 3, v46
    v_add_u32 v58, 0x130000, v58
    v_and_b32 v49, 7, v1
    v_lshlrev_b32 v49, 3, v49
    v_lshl_add_u32 v57, v46, 6, v49
    v_add_u32 v57, 0xe0000, v57
    v_lshlrev_b32 v41, 4, v0
    v_add_u32 v41, 158720, v41
    v_lshrrev_b32 v42, 2, v1
    v_lshlrev_b32 v42, 8, v42
    v_lshl_add_u32 v42, v2, 6, v42
    v_add_u32 v42, 158720, v42
    s_waitcnt vmcnt(48)
    v_readfirstlane_b32 s65, v40
    s_mul_i32 s64, s65, 0x9e3779b1
    s_add_u32 s64, s64, 0x7f4a7c15
    v_perm_b32 v24, v8, v8, v4
    v_perm_b32 v25, v8, v8, v5
    v_perm_b32 v26, v8, v8, v6
    v_perm_b32 v27, v8, v8, v7
    s_waitcnt vmcnt(46)
    v_swap_b32 v66, v68
    v_swap_b32 v67, v69
    v_perm_b32 v28, v9, v9, v4
    v_perm_b32 v29, v9, v9, v5
    v_perm_b32 v30, v9, v9, v6
    v_perm_b32 v31, v9, v9, v7
    v_mfma_f32_16x16x32_bf16 v[32:35], v[24:27], v[64:67], 0
    v_mfma_f32_16x16x32_bf16 v[36:39], v[24:27], v[68:71], 0
    s_waitcnt vmcnt(44)
    v_swap_b32 v74, v76
    v_swap_b32 v75, v77
    v_perm_b32 v24, v10, v10, v4
    v_perm_b32 v25, v10, v10, v5
    v_perm_b32 v26, v10, v10, v6
    v_perm_b32 v27, v10, v10, v7
    v_mfma_f32_16x16x32_bf16 v[32:35], v[28:31], v[72:75], v[32:35]
    v_mfma_f32_16x16x32_bf16 v[36:39], v[28:31], v[76:79], v[36:39]
    s_waitcnt vmcnt(42)
    v_swap_b32 v82, v84
    v_swap_b32 v83, v85
    v_perm_b32 v28, v11, v11, v4
    v_perm_b32 v29, v11, v11, v5
    v_perm_b32 v30, v11, v11, v6
    v_perm_b32 v31, v11, v11, v7
    v_mfma_f32_16x16x32_bf16 v[32:35], v[24:27], v[80:83], v[32:35]
    v_mfma_f32_16x16x32_bf16 v[36:39], v[24:27], v[84:87], v[36:39]
    s_waitcnt vmcnt(40)
    v_swap_b32 v90, v92
    v_swap_b32 v91, v93
    v_perm_b32 v24, v12, v12, v4
    v_perm_b32 v25, v12, v12, v5
    v_perm_b32 v26, v12, v12, v6
    v_perm_b32 v27, v12, v12, v7
    v_mfma_f32_16x16x32_bf16 v[32:35], v[28:31], v[88:91], v[32:35]
    v_mfma_f32_16x16x32_bf16 v[36:39], v[28:31], v[92:95], v[36:39]
    s_waitcnt vmcnt(38)
    v_swap_b32 v98, v100
    v_swap_b32 v99, v101
    v_perm_b32 v28, v13, v13, v4
    v_perm_b32 v29, v13, v13, v5
    v_perm_b32 v30, v13, v13, v6
    v_perm_b32 v31, v13, v13, v7
    v_mfma_f32_16x16x32_bf16 v[32:35], v[24:27], v[96:99], v[32:35]
    v_mfma_f32_16x16x32_bf16 v[36:39], v[24:27], v[100:103], v[36:39]
    s_waitcnt vmcnt(36)
    v_swap_b32 v106, v108
    v_swap_b32 v107, v109
    v_perm_b32 v24, v14, v14, v4
    v_perm_b32 v25, v14, v14, v5
    v_perm_b32 v26, v14, v14, v6
    v_perm_b32 v27, v14, v14, v7
    v_mfma_f32_16x16x32_bf16 v[32:35], v[28:31], v[104:107], v[32:35]
    v_mfma_f32_16x16x32_bf16 v[36:39], v[28:31], v[108:111], v[36:39]
    s_waitcnt vmcnt(34)
    v_swap_b32 v114, v116
    v_swap_b32 v115, v117
    v_perm_b32 v28, v15, v15, v4
    v_perm_b32 v29, v15, v15, v5
    v_perm_b32 v30, v15, v15, v6
    v_perm_b32 v31, v15, v15, v7
    v_mfma_f32_16x16x32_bf16 v[32:35], v[24:27], v[112:115], v[32:35]
    v_mfma_f32_16x16x32_bf16 v[36:39], v[24:27], v[116:119], v[36:39]
    s_waitcnt vmcnt(32)
    v_swap_b32 v122, v124
    v_swap_b32 v123, v125
    s_nop 1
    v_mfma_f32_16x16x32_bf16 v[32:35], v[28:31], v[120:123], v[32:35]
    v_mfma_f32_16x16x32_bf16 v[36:39], v[28:31], v[124:127], v[36:39]
    s_nop 6
    v_cvt_pk_bf16_f32 v242, v32, v33
    v_cvt_pk_bf16_f32 v243, v34, v35
    v_cvt_pk_bf16_f32 v244, v36, v37
    v_cvt_pk_bf16_f32 v245, v38, v39
    buffer_store_dwordx4 v[242:245], v52, s[52:55], 0 offen
    v_add3_u32 v46, v242, v243, v244
    v_add_u32 v46, v46, v245
    s_nop 1
    v_add_u32_dpp v46, v46, v46 quad_perm:[1,0,3,2] row_mask:0xf bank_mask:0xf
    s_nop 1
    v_add_u32_dpp v46, v46, v46 quad_perm:[2,3,0,1] row_mask:0xf bank_mask:0xf
    s_nop 1
    v_add_u32_dpp v46, v46, v46 row_half_mirror row_mask:0xf bank_mask:0xf
    s_nop 1
    v_add_u32_dpp v46, v46, v46 row_mirror row_mask:0xf bank_mask:0xf
    v_mov_b32 v48, v46
    s_nop 1
    v_permlane16_swap_b32 v46, v48
    v_add_u32 v46, v46, v48
    v_mov_b32 v48, v46
    s_nop 1
    v_permlane32_swap_b32 v46, v48
    v_add_u32 v46, v46, v48
    v_add_u32 v47, s64, v46
    s_mov_b64 s[74:75], exec
    s_mov_b64 exec, 1
    buffer_store_dwordx2 v[46:47], v53, s[52:55], 0 offen
    s_mov_b64 exec, s[74:75]
    v_mov_b32 v246, v46
    v_mov_b32 v247, v47
    s_mov_b32 s101, 0
    s_mov_b32 s72, 0
L_hopm_31:
    s_cmp_lg_u32 s72, 8
    s_cbranch_scc1 L_nosw_32
    buffer_store_dwordx4 v[242:245], v52, s[52:55], s3 offen sc1
    s_mov_b64 s[74:75], exec
    s_mov_b64 exec, 1
    buffer_store_dwordx2 v[246:247], v53, s[52:55], s3 offen sc1
    s_mov_b64 exec, s[74:75]
L_nosw_32:
    s_cmp_ge_u32 s72, 8
    s_cselect_b32 s101, s3, 0
    buffer_load_dwordx4 v[208:211], v54, s[52:55], s101 offen offset:0 sc1
    buffer_load_dwordx4 v[212:215], v55, s[52:55], s101 offen offset:0 sc1
    buffer_load_dwordx4 v[216:219], v54, s[52:55], s101 offen offset:256 sc1
    buffer_load_dwordx4 v[220:223], v55, s[52:55], s101 offen offset:256 sc1
    buffer_load_dwordx4 v[224:227], v54, s[52:55], s101 offen offset:512 sc1
    buffer_load_dwordx4 v[228:231], v55, s[52:55], s101 offen offset:512 sc1
    buffer_load_dwordx4 v[232:235], v54, s[52:55], s101 offen offset:768 sc1
    buffer_load_dwordx4 v[236:239], v55, s[52:55], s101 offen offset:768 sc1
    buffer_load_dwordx2 v[240:241], v56, s[52:55], s101 offen sc1
    s_waitcnt vmcnt(0)
    v_add_u32 v47, s64, v240
    v_cmp_ne_u32 vcc, v47, v241
    s_and_b64 s[78:79], vcc, s[4:5]
    v_add3_u32 v46, v208, v209, v210
    v_add3_u32 v46, v46, v211, v212
    v_add3_u32 v46, v46, v213, v214
    v_add3_u32 v46, v46, v215, v216
    v_add3_u32 v46, v46, v217, v218
    v_add3_u32 v46, v46, v219, v220
    v_add3_u32 v46, v46, v221, v222
    v_add_u32 v46, v46, v223
    v_add3_u32 v47, v224, v225, v226
    v_add3_u32 v47, v47, v227, v228
    v_add3_u32 v47, v47, v229, v230
    v_add3_u32 v47, v47, v231, v232
    v_add3_u32 v47, v47, v233, v234
    v_add3_u32 v47, v47, v235, v236
    v_add3_u32 v47, v47, v237, v238
    v_add_u32 v47, v47, v239
    v_add_u32 v46, v46, v47
    v_sub_u32 v46, v46, v240
    s_nop 1
    v_add_u32_dpp v46, v46, v46 quad_perm:[1,0,3,2] row_mask:0xf bank_mask:0xf
    v_swap_b32 v210, v212
    v_swap_b32 v211, v213
    v_add_u32_dpp v46, v46, v46 quad_perm:[2,3,0,1] row_mask:0xf bank_mask:0xf
    v_swap_b32 v218, v220
    v_swap_b32 v219, v221
    v_add_u32_dpp v46, v46, v46 row_half_mirror row_mask:0xf bank_mask:0xf
    v_swap_b32 v226, v228
    v_swap_b32 v227, v229
    v_add_u32_dpp v46, v46, v46 row_mirror row_mask:0xf bank_mask:0xf
    v_mov_b32 v48, v46
    v_swap_b32 v234, v236
    v_swap_b32 v235, v237
    v_permlane16_swap_b32 v46, v48
    v_add_u32 v46, v46, v48
    v_mov_b32 v48, v46
    v_mfma_f32_16x16x32_bf16 v[32:35], v[192:195], v[208:211], 0
    v_mfma_f32_16x16x32_bf16 v[36:39], v[192:195], v[212:215], 0
    v_permlane32_swap_b32 v46, v48
    v_add_u32 v46, v46, v48
    v_mfma_f32_16x16x32_bf16 v[32:35], v[196:199], v[216:219], v[32:35]
    v_mfma_f32_16x16x32_bf16 v[36:39], v[196:199], v[220:223], v[36:39]
    v_mfma_f32_16x16x32_bf16 v[32:35], v[200:203], v[224:227], v[32:35]
    v_mfma_f32_16x16x32_bf16 v[36:39], v[200:203], v[228:231], v[36:39]
    v_mfma_f32_16x16x32_bf16 v[32:35], v[204:207], v[232:235], v[32:35]
    v_mfma_f32_16x16x32_bf16 v[36:39], v[204:207], v[236:239], v[36:39]
    v_cmp_ne_u32 vcc, 0, v46
    s_or_b64 s[78:79], s[78:79], vcc
    s_cmp_eq_u64 s[78:79], 0
    s_cbranch_scc1 done_33
    s_add_u32 s72, s72, 1
    s_cmp_lt_u32 s72, 20000
    s_cbranch_scc1 L_hopm_31
done_33:
    s_mov_b32 s101, s72
    v_lshlrev_b32 v208, 16, v60
    v_and_b32 v209, 0xffff0000, v60
    v_lshlrev_b32 v210, 16, v61
    v_and_b32 v211, 0xffff0000, v61
    v_lshlrev_b32 v212, 16, v62
    v_and_b32 v213, 0xffff0000, v62
    v_lshlrev_b32 v214, 16, v63
    v_and_b32 v215, 0xffff0000, v63
    v_add_f32 v32, v32, v208
    v_add_f32 v33, v33, v209
    v_add_f32 v34, v34, v210
    v_add_f32 v35, v35, v211
    v_add_f32 v36, v36, v212
    v_add_f32 v37, v37, v213
    v_add_f32 v38, v38, v214
    v_add_f32 v39, v39, v215
    s_mov_b32 s66, 0xbfb8aa3b
    v_mul_f32 v208, s66, abs(v32)
    v_mul_f32 v209, s66, abs(v33)
    v_mul_f32 v210, s66, abs(v34)
    v_mul_f32 v211, s66, abs(v35)
    v_mul_f32 v212, s66, abs(v36)
    v_mul_f32 v213, s66, abs(v37)
    v_mul_f32 v214, s66, abs(v38)
    v_mul_f32 v215, s66, abs(v39)
    v_exp_f32 v208, v208
    v_exp_f32 v209, v209
    v_exp_f32 v210, v210
    v_exp_f32 v211, v211
    v_exp_f32 v212, v212
    v_exp_f32 v213, v213
    v_exp_f32 v214, v214
    v_exp_f32 v215, v215
    v_cmp_lt_f32 vcc, 0, v32
    v_mul_f32 v224, v208, v208
    s_nop 0
    v_cndmask_b32 v216, v224, 1.0, vcc
    v_fma_f32 v216, 2.0, v208, v216
    v_cndmask_b32 v224, 1.0, v224, vcc
    v_fma_f32 v224, 2.0, v224, v216
    v_rcp_f32 v224, v224
    v_mul_f32 v216, v216, v32
    v_mul_f32 v32, v216, v224
    v_cmp_lt_f32 vcc, 0, v33
    v_mul_f32 v225, v209, v209
    s_nop 0
    v_cndmask_b32 v217, v225, 1.0, vcc
    v_fma_f32 v217, 2.0, v209, v217
    v_cndmask_b32 v225, 1.0, v225, vcc
    v_fma_f32 v225, 2.0, v225, v217
    v_rcp_f32 v225, v225
    v_mul_f32 v217, v217, v33
    v_mul_f32 v33, v217, v225
    v_cmp_lt_f32 vcc, 0, v34
    v_mul_f32 v226, v210, v210
    s_nop 0
    v_cndmask_b32 v218, v226, 1.0, vcc
    v_fma_f32 v218, 2.0, v210, v218
    v_cndmask_b32 v226, 1.0, v226, vcc
    v_fma_f32 v226, 2.0, v226, v218
    v_rcp_f32 v226, v226
    v_mul_f32 v218, v218, v34
    v_mul_f32 v34, v218, v226
    v_cmp_lt_f32 vcc, 0, v35
    v_mul_f32 v227, v211, v211
    s_nop 0
    v_cndmask_b32 v219, v227, 1.0, vcc
    v_fma_f32 v219, 2.0, v211, v219
    v_cndmask_b32 v227, 1.0, v227, vcc
    v_fma_f32 v227, 2.0, v227, v219
    v_rcp_f32 v227, v227
    v_mul_f32 v219, v219, v35
    v_mul_f32 v35, v219, v227
    v_cmp_lt_f32 vcc, 0, v36
    v_mul_f32 v228, v212, v212
    s_nop 0
    v_cndmask_b32 v220, v228, 1.0, vcc
    v_fma_f32 v220, 2.0, v212, v220
    v_cndmask_b32 v228, 1.0, v228, vcc
    v_fma_f32 v228, 2.0, v228, v220
    v_rcp_f32 v228, v228
    v_mul_f32 v220, v220, v36
    v_mul_f32 v36, v220, v228
    v_cmp_lt_f32 vcc, 0, v37
    v_mul_f32 v229, v213, v213
    s_nop 0
    v_cndmask_b32 v221, v229, 1.0, vcc
    v_fma_f32 v221, 2.0, v213, v221
    v_cndmask_b32 v229, 1.0, v229, vcc
    v_fma_f32 v229, 2.0, v229, v221
    v_rcp_f32 v229, v229
    v_mul_f32 v221, v221, v37
    v_mul_f32 v37, v221, v229
    v_cmp_lt_f32 vcc, 0, v38
    v_mul_f32 v230, v214, v214
    s_nop 0
    v_cndmask_b32 v222, v230, 1.0, vcc
    v_fma_f32 v222, 2.0, v214, v222
    v_cndmask_b32 v230, 1.0, v230, vcc
    v_fma_f32 v230, 2.0, v230, v222
    v_rcp_f32 v230, v230
    v_mul_f32 v222, v222, v38
    v_mul_f32 v38, v222, v230
    v_cmp_lt_f32 vcc, 0, v39
    v_mul_f32 v231, v215, v215
    s_nop 0
    v_cndmask_b32 v223, v231, 1.0, vcc
    v_fma_f32 v223, 2.0, v215, v223
    v_cndmask_b32 v231, 1.0, v231, vcc
    v_fma_f32 v231, 2.0, v231, v223
    v_rcp_f32 v231, v231
    v_mul_f32 v223, v223, v39
    v_mul_f32 v39, v223, v231
    v_cvt_pk_bf16_f32 v16, v32, v33
    v_cvt_pk_bf16_f32 v17, v34, v35
    v_cvt_pk_bf16_f32 v18, v36, v37
    v_cvt_pk_bf16_f32 v19, v38, v39
    ds_write_b128 v41, v[16:19]
    ds_read_b128 v[8:11], v42 offset:0
    ds_read_b128 v[12:15], v42 offset:16
    ds_read_b128 v[16:19], v42 offset:32
    ds_read_b128 v[20:23], v42 offset:48
    v_lshlrev_b32 v45, 2, v2
    v_add_u32 v45, 153600, v45
    s_mov_b32 s73, 0
L_fw_34:
    ds_read_b32 v46, v3 offset:44
    ds_read_b32 v59, v45
    s_waitcnt lgkmcnt(0)
    v_cmp_gt_u32 vcc, 1, v46
    s_cbranch_vccz L_fd_35
    s_add_u32 s73, s73, 1
    s_cmp_lt_u32 s73, 2000000
    s_cbranch_scc1 L_fw_34
L_fd_35:
    v_perm_b32 v24, v8, v8, v4
    v_perm_b32 v25, v8, v8, v5
    v_perm_b32 v26, v8, v8, v6
    v_perm_b32 v27, v8, v8, v7
    v_perm_b32 v28, v9, v9, v4
    v_perm_b32 v29, v9, v9, v5
    v_perm_b32 v30, v9, v9, v6
    v_perm_b32 v31, v9, v9, v7
    v_mfma_f32_16x16x32_bf16 v[32:35], v[24:27], v[128:131], 0
    v_perm_b32 v24, v10, v10, v4
    v_perm_b32 v25, v10, v10, v5
    v_perm_b32 v26, v10, v10, v6
    v_perm_b32 v27, v10, v10, v7
    v_mfma_f32_16x16x32_bf16 v[32:35], v[28:31], v[132:135], v[32:35]
    v_perm_b32 v28, v11, v11, v4
    v_perm_b32 v29, v11, v11, v5
    v_perm_b32 v30, v11, v11, v6
    v_perm_b32 v31, v11, v11, v7
    v_mfma_f32_16x16x32_bf16 v[32:35], v[24:27], v[136:139], v[32:35]
    v_perm_b32 v24, v12, v12, v4
    v_perm_b32 v25, v12, v12, v5
    v_perm_b32 v26, v12, v12, v6
    v_perm_b32 v27, v12, v12, v7
    v_mfma_f32_16x16x32_bf16 v[32:35], v[28:31], v[140:143], v[32:35]
    v_perm_b32 v28, v13, v13, v4
    v_perm_b32 v29, v13, v13, v5
    v_perm_b32 v30, v13, v13, v6
    v_perm_b32 v31, v13, v13, v7
    v_mfma_f32_16x16x32_bf16 v[32:35], v[24:27], v[144:147], v[32:35]
    v_perm_b32 v24, v14, v14, v4
    v_perm_b32 v25, v14, v14, v5
    v_perm_b32 v26, v14, v14, v6
    v_perm_b32 v27, v14, v14, v7
    v_mfma_f32_16x16x32_bf16 v[32:35], v[28:31], v[148:151], v[32:35]
    v_perm_b32 v28, v15, v15, v4
    v_perm_b32 v29, v15, v15, v5
    v_perm_b32 v30, v15, v15, v6
    v_perm_b32 v31, v15, v15, v7
    v_mfma_f32_16x16x32_bf16 v[32:35], v[24:27], v[152:155], v[32:35]
    v_perm_b32 v24, v16, v16, v4
    v_perm_b32 v25, v16, v16, v5
    v_perm_b32 v26, v16, v16, v6
    v_perm_b32 v27, v16, v16, v7
    v_mfma_f32_16x16x32_bf16 v[32:35], v[28:31], v[156:159], v[32:35]
    v_perm_b32 v28, v17, v17, v4
    v_perm_b32 v29, v17, v17, v5
    v_perm_b32 v30, v17, v17, v6
    v_perm_b32 v31, v17, v17, v7
    v_mfma_f32_16x16x32_bf16 v[32:35], v[24:27], v[160:163], v[32:35]
    v_perm_b32 v24, v18, v18, v4
    v_perm_b32 v25, v18, v18, v5
    v_perm_b32 v26, v18, v18, v6
    v_perm_b32 v27, v18, v18, v7
    v_mfma_f32_16x16x32_bf16 v[32:35], v[28:31], v[164:167], v[32:35]
    v_perm_b32 v28, v19, v19, v4
    v_perm_b32 v29, v19, v19, v5
    v_perm_b32 v30, v19, v19, v6
    v_perm_b32 v31, v19, v19, v7
    v_mfma_f32_16x16x32_bf16 v[32:35], v[24:27], v[168:171], v[32:35]
    v_perm_b32 v24, v20, v20, v4
    v_perm_b32 v25, v20, v20, v5
    v_perm_b32 v26, v20, v20, v6
    v_perm_b32 v27, v20, v20, v7
    v_mfma_f32_16x16x32_bf16 v[32:35], v[28:31], v[172:175], v[32:35]
    v_perm_b32 v28, v21, v21, v4
    v_perm_b32 v29, v21, v21, v5
    v_perm_b32 v30, v21, v21, v6
    v_perm_b32 v31, v21, v21, v7
    v_mfma_f32_16x16x32_bf16 v[32:35], v[24:27], v[176:179], v[32:35]
    v_perm_b32 v24, v22, v22, v4
    v_perm_b32 v25, v22, v22, v5
    v_perm_b32 v26, v22, v22, v6
    v_perm_b32 v27, v22, v22, v7
    v_mfma_f32_16x16x32_bf16 v[32:35], v[28:31], v[180:183], v[32:35]
    v_perm_b32 v28, v23, v23, v4
    v_perm_b32 v29, v23, v23, v5
    v_perm_b32 v30, v23, v23, v6
    v_perm_b32 v31, v23, v23, v7
    v_mfma_f32_16x16x32_bf16 v[32:35], v[24:27], v[184:187], v[32:35]
    s_nop 0
    v_mfma_f32_16x16x32_bf16 v[32:35], v[28:31], v[188:191], v[32:35]
    v_sub_f32 v59, 1.0, v59
    s_nop 6
    v_mul_f32 v32, v32, v59
    v_mul_f32 v33, v33, v59
    v_mul_f32 v34, v34, v59
    v_mul_f32 v35, v35, v59
    v_cvt_pk_bf16_f32 v16, v32, v33
    v_cvt_pk_bf16_f32 v17, v34, v35
    buffer_store_dwordx2 v[16:17], v57, s[52:55], 0 offen sc1
    v_add_u32 v46, v16, v17
    s_nop 1
    v_add_u32_dpp v46, v46, v46 quad_perm:[1,0,3,2] row_mask:0xf bank_mask:0xf
    s_nop 1
    v_add_u32_dpp v46, v46, v46 quad_perm:[2,3,0,1] row_mask:0xf bank_mask:0xf
    s_nop 1
    v_add_u32_dpp v46, v46, v46 row_half_mirror row_mask:0xf bank_mask:0xf
    v_add_u32 v47, s64, v46
    s_mov_b32 exec_lo, 0x01010101
    s_mov_b32 exec_hi, 0x01010101
    buffer_store_dwordx2 v[46:47], v58, s[52:55], 0 offen sc1
    s_mov_b64 exec, -1
    s_cmp_ge_u32 s101, 8
    s_cbranch_scc1 L_nocp_36
    buffer_store_dwordx4 v[242:245], v52, s[52:55], s3 offen sc1
    s_mov_b64 s[74:75], exec
    s_mov_b64 exec, 1
    buffer_store_dwordx2 v[246:247], v53, s[52:55], s3 offen sc1
    s_mov_b64 exec, s[74:75]
L_nocp_36:
    s_branch L_Ldone
L_tail:
    s_lshl_b32 s66, s60, 19
    s_lshl_b32 s67, s61, 8
    s_add_u32 s66, s66, s67
    v_lshlrev_b32 v41, 17, v2
    v_lshl_add_u32 v41, v1, 4, v41
    v_add_u32 v41, s66, v41
    s_lshl_b32 s66, s61, 17
    s_lshl_b32 s67, s60, 7
    s_add_u32 s66, s66, s67
    v_lshlrev_b32 v42, 15, v2
    v_lshl_add_u32 v42, v1, 3, v42
    v_add_u32 v42, s66, v42
    buffer_load_dword v61, v43, s[52:55], 0 offen sc1
    s_lshl_b32 s66, s100, 10
    s_add_u32 s66, s66, 0x90000
    v_lshl_add_u32 v52, v0, 4, s66
    s_lshl_b32 s66, s100, 3
    s_add_u32 s66, s66, 0xd0000
    v_mov_b32 v53, s66
    s_lshl_b32 s66, s61, 13
    s_add_u32 s66, s66, 0x90000
    v_lshlrev_b32 v46, 10, v2
    v_lshl_add_u32 v46, v1, 4, v46
    v_add_u32 v54, s66, v46
    v_add_u32 v55, 4096, v54
    s_lshl_b32 s66, s61, 6
    s_add_u32 s66, s66, 0xd0000
    v_lshl_add_u32 v46, v0, 3, s66
    v_cmp_gt_u32 s[4:5], 8, v0
    v_mov_b32 v47, 0x7ffffff0
    s_nop 0
    v_cndmask_b32 v56, v47, v46, s[4:5]
    v_lshrrev_b32 v46, 3, v1
    v_lshl_add_u32 v46, v2, 4, v46
    s_lshl_b32 s66, s60, 1
    v_add_u32 v46, s66, v46
    s_movk_i32 s67, 48
    v_mul_lo_u32 v46, v46, s67
    v_add_u32 v46, s61, v46
    v_lshlrev_b32 v60, 3, v46
    v_add_u32 v60, 0x130000, v60
    v_and_b32 v47, 7, v1
    v_lshlrev_b32 v47, 3, v47
    v_lshl_add_u32 v59, v46, 6, v47
    v_add_u32 v59, 0xe0000, v59
    s_mov_b32 s73, 0
L_fw_37:
    ds_read_b32 v45, v3 offset:8
    s_waitcnt lgkmcnt(0)
    v_cmp_gt_u32 vcc, 4, v45
    s_cbranch_vccz L_fd_38
    s_add_u32 s73, s73, 1
    s_cmp_lt_u32 s73, 2000000
    s_cbranch_scc1 L_fw_37
L_fd_38:
    s_mov_b32 s68, 0
    buffer_load_dwordx4 v[64:67], v41, s[24:27], s68 offen nt
    s_add_u32 s68, s68, 8192
    buffer_load_dwordx4 v[68:71], v41, s[24:27], s68 offen nt
    s_add_u32 s68, s68, 8192
    buffer_load_dwordx4 v[72:75], v41, s[24:27], s68 offen nt
    s_add_u32 s68, s68, 8192
    buffer_load_dwordx4 v[76:79], v41, s[24:27], s68 offen nt
    s_add_u32 s68, s68, 8192
    buffer_load_dwordx4 v[80:83], v41, s[24:27], s68 offen nt
    s_add_u32 s68, s68, 8192
    buffer_load_dwordx4 v[84:87], v41, s[24:27], s68 offen nt
    s_add_u32 s68, s68, 8192
    buffer_load_dwordx4 v[88:91], v41, s[24:27], s68 offen nt
    s_add_u32 s68, s68, 8192
    buffer_load_dwordx4 v[92:95], v41, s[24:27], s68 offen nt
    s_add_u32 s68, s68, 8192
    buffer_load_dwordx4 v[96:99], v41, s[24:27], s68 offen nt
    s_add_u32 s68, s68, 8192
    buffer_load_dwordx4 v[100:103], v41, s[24:27], s68 offen nt
    s_add_u32 s68, s68, 8192
    buffer_load_dwordx4 v[104:107], v41, s[24:27], s68 offen nt
    s_add_u32 s68, s68, 8192
    buffer_load_dwordx4 v[108:111], v41, s[24:27], s68 offen nt
    s_add_u32 s68, s68, 8192
    buffer_load_dwordx4 v[112:115], v41, s[24:27], s68 offen nt
    s_add_u32 s68, s68, 8192
    buffer_load_dwordx4 v[116:119], v41, s[24:27], s68 offen nt
    s_add_u32 s68, s68, 8192
    buffer_load_dwordx4 v[120:123], v41, s[24:27], s68 offen nt
    s_add_u32 s68, s68, 8192
    buffer_load_dwordx4 v[124:127], v41, s[24:27], s68 offen nt
    v_mov_b32 v62, v42
    s_waitcnt vmcnt(16)
    v_readfirstlane_b32 s65, v61
    s_mul_i32 s64, s65, 0x9e3779b1
    s_add_u32 s64, s64, 0x7f4a7c15
    v_lshlrev_b32 v45, 2, v2
    v_add_u32 v45, 153600, v45
    s_mov_b32 s73, 0
L_fw_39:
    ds_read_b32 v46, v3 offset:44
    ds_read_b32 v58, v45
    s_waitcnt lgkmcnt(0)
    v_cmp_gt_u32 vcc, 1, v46
    s_cbranch_vccz L_fd_40
    s_add_u32 s73, s73, 1
    s_cmp_lt_u32 s73, 2000000
    s_cbranch_scc1 L_fw_39
L_fd_40:
    v_and_b32 v46, 3, v1
    v_lshrrev_b32 v47, 2, v1
    v_mov_b32 v48, 0
    v_mov_b32 v49, 0x3f80
    v_cmp_eq_u32 vcc, 0, v46
    s_nop 1
    v_cndmask_b32 v50, v48, v49, vcc
    v_mov_b32 v49, 0x3f800000
    v_cmp_eq_u32 vcc, 1, v46
    s_nop 1
    v_cndmask_b32 v50, v50, v49, vcc
    v_mov_b32 v49, 0x3f80
    v_cmp_eq_u32 vcc, 2, v46
    s_nop 1
    v_cndmask_b32 v51, v48, v49, vcc
    v_mov_b32 v49, 0x3f800000
    v_cmp_eq_u32 vcc, 3, v46
    s_nop 1
    v_cndmask_b32 v51, v51, v49, vcc
    v_cmp_eq_u32 vcc, 0, v47
    s_nop 1
    v_cndmask_b32 v192, v48, v50, vcc
    v_cndmask_b32 v193, v48, v51, vcc
    v_mov_b32 v194, v192
    v_mov_b32 v195, v193
    v_cmp_eq_u32 vcc, 1, v47
    s_nop 1
    v_cndmask_b32 v196, v48, v50, vcc
    v_cndmask_b32 v197, v48, v51, vcc
    v_mov_b32 v198, v196
    v_mov_b32 v199, v197
    v_cmp_eq_u32 vcc, 2, v47
    s_nop 1
    v_cndmask_b32 v200, v48, v50, vcc
    v_cndmask_b32 v201, v48, v51, vcc
    v_mov_b32 v202, v200
    v_mov_b32 v203, v201
    v_cmp_eq_u32 vcc, 3, v47
    s_nop 1
    v_cndmask_b32 v204, v48, v50, vcc
    v_cndmask_b32 v205, v48, v51, vcc
    v_mov_b32 v206, v204
    v_mov_b32 v207, v205
    v_lshrrev_b32 v44, 2, v1
    v_lshlrev_b32 v42, 7, v44
    v_lshl_add_u32 v42, v2, 5, v42
    v_add_u32 v42, 158208, v42
    v_lshlrev_b32 v43, 4, v0
    v_add_u32 v43, 160768, v43
    v_lshlrev_b32 v44, 8, v44
    v_lshl_add_u32 v44, v2, 6, v44
    v_add_u32 v44, 160768, v44
    s_waitcnt vmcnt(0)
    v_swap_b32 v66, v68
    v_swap_b32 v67, v69
    v_swap_b32 v74, v76
    v_swap_b32 v75, v77
    v_swap_b32 v82, v84
    v_swap_b32 v83, v85
    v_swap_b32 v90, v92
    v_swap_b32 v91, v93
    v_swap_b32 v98, v100
    v_swap_b32 v99, v101
    v_swap_b32 v106, v108
    v_swap_b32 v107, v109
    v_swap_b32 v114, v116
    v_swap_b32 v115, v117
    v_swap_b32 v122, v124
    v_swap_b32 v123, v125
    s_mov_b32 s73, 0
L_fw_41:
    ds_read_b32 v45, v3 offset:24
    s_waitcnt lgkmcnt(0)
    v_cmp_gt_u32 vcc, 1, v45
    s_cbranch_vccz L_fd_42
    s_add_u32 s73, s73, 1
    s_cmp_lt_u32 s73, 2000000
    s_cbranch_scc1 L_fw_41
L_fd_42:
    s_mov_b32 s68, 0
    buffer_load_dwordx2 v[128:129], v62, s[28:31], s68 offen offset:0 nt
    buffer_load_dwordx2 v[130:131], v62, s[28:31], s68 offen offset:1024 nt
    buffer_load_dwordx2 v[132:133], v62, s[28:31], s68 offen offset:2048 nt
    buffer_load_dwordx2 v[134:135], v62, s[28:31], s68 offen offset:3072 nt
    s_add_u32 s68, s68, 4096
    buffer_load_dwordx2 v[136:137], v62, s[28:31], s68 offen offset:0 nt
    buffer_load_dwordx2 v[138:139], v62, s[28:31], s68 offen offset:1024 nt
    buffer_load_dwordx2 v[140:141], v62, s[28:31], s68 offen offset:2048 nt
    buffer_load_dwordx2 v[142:143], v62, s[28:31], s68 offen offset:3072 nt
    s_add_u32 s68, s68, 4096
    buffer_load_dwordx2 v[144:145], v62, s[28:31], s68 offen offset:0 nt
    buffer_load_dwordx2 v[146:147], v62, s[28:31], s68 offen offset:1024 nt
    buffer_load_dwordx2 v[148:149], v62, s[28:31], s68 offen offset:2048 nt
    buffer_load_dwordx2 v[150:151], v62, s[28:31], s68 offen offset:3072 nt
    s_add_u32 s68, s68, 4096
    buffer_load_dwordx2 v[152:153], v62, s[28:31], s68 offen offset:0 nt
    buffer_load_dwordx2 v[154:155], v62, s[28:31], s68 offen offset:1024 nt
    buffer_load_dwordx2 v[156:157], v62, s[28:31], s68 offen offset:2048 nt
    buffer_load_dwordx2 v[158:159], v62, s[28:31], s68 offen offset:3072 nt
    s_add_u32 s68, s68, 4096
    buffer_load_dwordx2 v[160:161], v62, s[28:31], s68 offen offset:0 nt
    buffer_load_dwordx2 v[162:163], v62, s[28:31], s68 offen offset:1024 nt
    buffer_load_dwordx2 v[164:165], v62, s[28:31], s68 offen offset:2048 nt
    buffer_load_dwordx2 v[166:167], v62, s[28:31], s68 offen offset:3072 nt
    s_add_u32 s68, s68, 4096
    buffer_load_dwordx2 v[168:169], v62, s[28:31], s68 offen offset:0 nt
    buffer_load_dwordx2 v[170:171], v62, s[28:31], s68 offen offset:1024 nt
    buffer_load_dwordx2 v[172:173], v62, s[28:31], s68 offen offset:2048 nt
    buffer_load_dwordx2 v[174:175], v62, s[28:31], s68 offen offset:3072 nt
    s_add_u32 s68, s68, 4096
    buffer_load_dwordx2 v[176:177], v62, s[28:31], s68 offen offset:0 nt
    buffer_load_dwordx2 v[178:179], v62, s[28:31], s68 offen offset:1024 nt
    buffer_load_dwordx2 v[180:181], v62, s[28:31], s68 offen offset:2048 nt
    buffer_load_dwordx2 v[182:183], v62, s[28:31], s68 offen offset:3072 nt
    s_add_u32 s68, s68, 4096
    buffer_load_dwordx2 v[184:185], v62, s[28:31], s68 offen offset:0 nt
    buffer_load_dwordx2 v[186:187], v62, s[28:31], s68 offen offset:1024 nt
    buffer_load_dwordx2 v[188:189], v62, s[28:31], s68 offen offset:2048 nt
    buffer_load_dwordx2 v[190:191], v62, s[28:31], s68 offen offset:3072 nt
    s_mov_b32 s73, 0
L_cc_43:
    ds_read_b128 v[8:11], v42
    ds_read_b128 v[12:15], v42 offset:16
    s_waitcnt lgkmcnt(0)
    v_max3_u32 v45, v8, v9, v10
    v_max3_u32 v46, v11, v12, v13
    v_max3_u32 v45, v45, v14, v15
    v_max_u32 v45, v45, v46
    v_cmp_eq_u32 vcc, -1, v45
    s_cbranch_vccz L_ccd_44
    s_add_u32 s73, s73, 1
    s_cmp_lt_u32 s73, 4000000
    s_cbranch_scc1 L_cc_43
L_ccd_44:
    v_perm_b32 v24, v8, v8, v4
    v_perm_b32 v25, v8, v8, v5
    v_perm_b32 v26, v8, v8, v6
    v_perm_b32 v27, v8, v8, v7
    v_perm_b32 v28, v9, v9, v4
    v_perm_b32 v29, v9, v9, v5
    v_perm_b32 v30, v9, v9, v6
    v_perm_b32 v31, v9, v9, v7
    v_mfma_f32_16x16x32_bf16 v[32:35], v[24:27], v[64:67], 0
    v_mfma_f32_16x16x32_bf16 v[36:39], v[24:27], v[68:71], 0
    v_perm_b32 v24, v10, v10, v4
    v_perm_b32 v25, v10, v10, v5
    v_perm_b32 v26, v10, v10, v6
    v_perm_b32 v27, v10, v10, v7
    v_mfma_f32_16x16x32_bf16 v[32:35], v[28:31], v[72:75], v[32:35]
    v_mfma_f32_16x16x32_bf16 v[36:39], v[28:31], v[76:79], v[36:39]
    v_perm_b32 v28, v11, v11, v4
    v_perm_b32 v29, v11, v11, v5
    v_perm_b32 v30, v11, v11, v6
    v_perm_b32 v31, v11, v11, v7
    v_mfma_f32_16x16x32_bf16 v[32:35], v[24:27], v[80:83], v[32:35]
    v_mfma_f32_16x16x32_bf16 v[36:39], v[24:27], v[84:87], v[36:39]
    v_perm_b32 v24, v12, v12, v4
    v_perm_b32 v25, v12, v12, v5
    v_perm_b32 v26, v12, v12, v6
    v_perm_b32 v27, v12, v12, v7
    v_mfma_f32_16x16x32_bf16 v[32:35], v[28:31], v[88:91], v[32:35]
    v_mfma_f32_16x16x32_bf16 v[36:39], v[28:31], v[92:95], v[36:39]
    v_perm_b32 v28, v13, v13, v4
    v_perm_b32 v29, v13, v13, v5
    v_perm_b32 v30, v13, v13, v6
    v_perm_b32 v31, v13, v13, v7
    v_mfma_f32_16x16x32_bf16 v[32:35], v[24:27], v[96:99], v[32:35]
    v_mfma_f32_16x16x32_bf16 v[36:39], v[24:27], v[100:103], v[36:39]
    v_perm_b32 v24, v14, v14, v4
    v_perm_b32 v25, v14, v14, v5
    v_perm_b32 v26, v14, v14, v6
    v_perm_b32 v27, v14, v14, v7
    v_mfma_f32_16x16x32_bf16 v[32:35], v[28:31], v[104:107], v[32:35]
    v_mfma_f32_16x16x32_bf16 v[36:39], v[28:31], v[108:111], v[36:39]
    v_perm_b32 v28, v15, v15, v4
    v_perm_b32 v29, v15, v15, v5
    v_perm_b32 v30, v15, v15, v6
    v_perm_b32 v31, v15, v15, v7
    v_mfma_f32_16x16x32_bf16 v[32:35], v[24:27], v[112:115], v[32:35]
    v_mfma_f32_16x16x32_bf16 v[36:39], v[24:27], v[116:119], v[36:39]
    v_mfma_f32_16x16x32_bf16 v[32:35], v[28:31], v[120:123], v[32:35]
    v_mfma_f32_16x16x32_bf16 v[36:39], v[28:31], v[124:127], v[36:39]
    s_nop 6
    v_cvt_pk_bf16_f32 v242, v32, v33
    v_cvt_pk_bf16_f32 v243, v34, v35
    v_cvt_pk_bf16_f32 v244, v36, v37
    v_cvt_pk_bf16_f32 v245, v38, v39
    buffer_store_dwordx4 v[242:245], v52, s[52:55], 0 offen
    v_add3_u32 v46, v242, v243, v244
    v_add_u32 v46, v46, v245
    s_nop 1
    v_add_u32_dpp v46, v46, v46 quad_perm:[1,0,3,2] row_mask:0xf bank_mask:0xf
    s_nop 1
    v_add_u32_dpp v46, v46, v46 quad_perm:[2,3,0,1] row_mask:0xf bank_mask:0xf
    s_nop 1
    v_add_u32_dpp v46, v46, v46 row_half_mirror row_mask:0xf bank_mask:0xf
    s_nop 1
    v_add_u32_dpp v46, v46, v46 row_mirror row_mask:0xf bank_mask:0xf
    v_mov_b32 v48, v46
    s_nop 1
    v_permlane16_swap_b32 v46, v48
    v_add_u32 v46, v46, v48
    v_mov_b32 v48, v46
    s_nop 1
    v_permlane32_swap_b32 v46, v48
    v_add_u32 v46, v46, v48
    v_add_u32 v47, s64, v46
    s_mov_b64 s[74:75], exec
    s_mov_b64 exec, 1
    buffer_store_dwordx2 v[46:47], v53, s[52:55], 0 offen
    s_mov_b64 exec, s[74:75]
    v_mov_b32 v246, v46
    v_mov_b32 v247, v47
    s_mov_b32 s101, 0
    s_mov_b32 s72, 0
L_hop4_45:
    s_cmp_lg_u32 s72, 8
    s_cbranch_scc1 L_nosw_46
    buffer_store_dwordx4 v[242:245], v52, s[52:55], s3 offen sc1
    s_mov_b64 s[74:75], exec
    s_mov_b64 exec, 1
    buffer_store_dwordx2 v[246:247], v53, s[52:55], s3 offen sc1
    s_mov_b64 exec, s[74:75]
L_nosw_46:
    s_cmp_ge_u32 s72, 8
    s_cselect_b32 s101, s3, 0
    buffer_load_dwordx4 v[208:211], v54, s[52:55], s101 offen offset:0 sc1
    buffer_load_dwordx4 v[212:215], v55, s[52:55], s101 offen offset:0 sc1
    buffer_load_dwordx4 v[216:219], v54, s[52:55], s101 offen offset:256 sc1
    buffer_load_dwordx4 v[220:223], v55, s[52:55], s101 offen offset:256 sc1
    buffer_load_dwordx4 v[224:227], v54, s[52:55], s101 offen offset:512 sc1
    buffer_load_dwordx4 v[228:231], v55, s[52:55], s101 offen offset:512 sc1
    buffer_load_dwordx4 v[232:235], v54, s[52:55], s101 offen offset:768 sc1
    buffer_load_dwordx4 v[236:239], v55, s[52:55], s101 offen offset:768 sc1
    buffer_load_dwordx2 v[240:241], v56, s[52:55], s101 offen sc1
    s_waitcnt vmcnt(0)
    v_add_u32 v47, s64, v240
    v_cmp_ne_u32 vcc, v47, v241
    s_and_b64 s[78:79], vcc, s[4:5]
    v_add3_u32 v46, v208, v209, v210
    v_add3_u32 v46, v46, v211, v212
    v_add3_u32 v46, v46, v213, v214
    v_add3_u32 v46, v46, v215, v216
    v_add3_u32 v46, v46, v217, v218
    v_add3_u32 v46, v46, v219, v220
    v_add3_u32 v46, v46, v221, v222
    v_add_u32 v46, v46, v223
    v_add3_u32 v47, v224, v225, v226
    v_add3_u32 v47, v47, v227, v228
    v_add3_u32 v47, v47, v229, v230
    v_add3_u32 v47, v47, v231, v232
    v_add3_u32 v47, v47, v233, v234
    v_add3_u32 v47, v47, v235, v236
    v_add3_u32 v47, v47, v237, v238
    v_add_u32 v47, v47, v239
    v_add_u32 v46, v46, v47
    v_sub_u32 v46, v46, v240
    s_nop 1
    v_add_u32_dpp v46, v46, v46 quad_perm:[1,0,3,2] row_mask:0xf bank_mask:0xf
    v_swap_b32 v210, v212
    v_swap_b32 v211, v213
    v_add_u32_dpp v46, v46, v46 quad_perm:[2,3,0,1] row_mask:0xf bank_mask:0xf
    v_swap_b32 v218, v220
    v_swap_b32 v219, v221
    v_add_u32_dpp v46, v46, v46 row_half_mirror row_mask:0xf bank_mask:0xf
    v_swap_b32 v226, v228
    v_swap_b32 v227, v229
    v_add_u32_dpp v46, v46, v46 row_mirror row_mask:0xf bank_mask:0xf
    v_mov_b32 v48, v46
    v_swap_b32 v234, v236
    v_swap_b32 v235, v237
    v_permlane16_swap_b32 v46, v48
    v_add_u32 v46, v46, v48
    v_mov_b32 v48, v46
    v_mfma_f32_16x16x32_bf16 v[32:35], v[192:195], v[208:211], 0
    v_mfma_f32_16x16x32_bf16 v[36:39], v[192:195], v[212:215], 0
    v_permlane32_swap_b32 v46, v48
    v_add_u32 v46, v46, v48
    v_mfma_f32_16x16x32_bf16 v[32:35], v[196:199], v[216:219], v[32:35]
    v_mfma_f32_16x16x32_bf16 v[36:39], v[196:199], v[220:223], v[36:39]
    v_mfma_f32_16x16x32_bf16 v[32:35], v[200:203], v[224:227], v[32:35]
    v_mfma_f32_16x16x32_bf16 v[36:39], v[200:203], v[228:231], v[36:39]
    v_mfma_f32_16x16x32_bf16 v[32:35], v[204:207], v[232:235], v[32:35]
    v_mfma_f32_16x16x32_bf16 v[36:39], v[204:207], v[236:239], v[36:39]
    v_cmp_ne_u32 vcc, 0, v46
    s_or_b64 s[78:79], s[78:79], vcc
    s_cmp_eq_u64 s[78:79], 0
    s_cbranch_scc1 done_47
    s_add_u32 s72, s72, 1
    s_cmp_lt_u32 s72, 20000
    s_cbranch_scc1 L_hop4_45
done_47:
    s_mov_b32 s101, s72
    v_cvt_pk_bf16_f32 v16, v32, v33
    v_cvt_pk_bf16_f32 v17, v34, v35
    v_cvt_pk_bf16_f32 v18, v36, v37
    v_cvt_pk_bf16_f32 v19, v38, v39
    ds_write_b128 v43, v[16:19]
    ds_read_b128 v[8:11], v44 offset:0
    ds_read_b128 v[12:15], v44 offset:16
    ds_read_b128 v[16:19], v44 offset:32
    ds_read_b128 v[20:23], v44 offset:48
    s_waitcnt lgkmcnt(3)
    v_perm_b32 v24, v8, v8, v4
    v_perm_b32 v25, v8, v8, v5
    v_perm_b32 v26, v8, v8, v6
    v_perm_b32 v27, v8, v8, v7
    v_perm_b32 v28, v9, v9, v4
    v_perm_b32 v29, v9, v9, v5
    v_perm_b32 v30, v9, v9, v6
    v_perm_b32 v31, v9, v9, v7
    v_mfma_f32_16x16x32_bf16 v[32:35], v[24:27], v[128:131], 0
    v_perm_b32 v24, v10, v10, v4
    v_perm_b32 v25, v10, v10, v5
    v_perm_b32 v26, v10, v10, v6
    v_perm_b32 v27, v10, v10, v7
    v_mfma_f32_16x16x32_bf16 v[32:35], v[28:31], v[132:135], v[32:35]
    v_perm_b32 v28, v11, v11, v4
    v_perm_b32 v29, v11, v11, v5
    v_perm_b32 v30, v11, v11, v6
    v_perm_b32 v31, v11, v11, v7
    v_mfma_f32_16x16x32_bf16 v[32:35], v[24:27], v[136:139], v[32:35]
    s_waitcnt lgkmcnt(2)
    v_perm_b32 v24, v12, v12, v4
    v_perm_b32 v25, v12, v12, v5
    v_perm_b32 v26, v12, v12, v6
    v_perm_b32 v27, v12, v12, v7
    v_mfma_f32_16x16x32_bf16 v[32:35], v[28:31], v[140:143], v[32:35]
    v_perm_b32 v28, v13, v13, v4
    v_perm_b32 v29, v13, v13, v5
    v_perm_b32 v30, v13, v13, v6
    v_perm_b32 v31, v13, v13, v7
    v_mfma_f32_16x16x32_bf16 v[32:35], v[24:27], v[144:147], v[32:35]
    v_perm_b32 v24, v14, v14, v4
    v_perm_b32 v25, v14, v14, v5
    v_perm_b32 v26, v14, v14, v6
    v_perm_b32 v27, v14, v14, v7
    v_mfma_f32_16x16x32_bf16 v[32:35], v[28:31], v[148:151], v[32:35]
    v_perm_b32 v28, v15, v15, v4
    v_perm_b32 v29, v15, v15, v5
    v_perm_b32 v30, v15, v15, v6
    v_perm_b32 v31, v15, v15, v7
    v_mfma_f32_16x16x32_bf16 v[32:35], v[24:27], v[152:155], v[32:35]
    s_waitcnt lgkmcnt(1)
    v_perm_b32 v24, v16, v16, v4
    v_perm_b32 v25, v16, v16, v5
    v_perm_b32 v26, v16, v16, v6
    v_perm_b32 v27, v16, v16, v7
    v_mfma_f32_16x16x32_bf16 v[32:35], v[28:31], v[156:159], v[32:35]
    v_perm_b32 v28, v17, v17, v4
    v_perm_b32 v29, v17, v17, v5
    v_perm_b32 v30, v17, v17, v6
    v_perm_b32 v31, v17, v17, v7
    v_mfma_f32_16x16x32_bf16 v[32:35], v[24:27], v[160:163], v[32:35]
    v_perm_b32 v24, v18, v18, v4
    v_perm_b32 v25, v18, v18, v5
    v_perm_b32 v26, v18, v18, v6
    v_perm_b32 v27, v18, v18, v7
    v_mfma_f32_16x16x32_bf16 v[32:35], v[28:31], v[164:167], v[32:35]
    v_perm_b32 v28, v19, v19, v4
    v_perm_b32 v29, v19, v19, v5
    v_perm_b32 v30, v19, v19, v6
    v_perm_b32 v31, v19, v19, v7
    v_mfma_f32_16x16x32_bf16 v[32:35], v[24:27], v[168:171], v[32:35]
    s_waitcnt lgkmcnt(0)
    v_perm_b32 v24, v20, v20, v4
    v_perm_b32 v25, v20, v20, v5
    v_perm_b32 v26, v20, v20, v6
    v_perm_b32 v27, v20, v20, v7
    v_mfma_f32_16x16x32_bf16 v[32:35], v[28:31], v[172:175], v[32:35]
    v_perm_b32 v28, v21, v21, v4
    v_perm_b32 v29, v21, v21, v5
    v_perm_b32 v30, v21, v21, v6
    v_perm_b32 v31, v21, v21, v7
    v_mfma_f32_16x16x32_bf16 v[32:35], v[24:27], v[176:179], v[32:35]
    v_perm_b32 v24, v22, v22, v4
    v_perm_b32 v25, v22, v22, v5
    v_perm_b32 v26, v22, v22, v6
    v_perm_b32 v27, v22, v22, v7
    v_mfma_f32_16x16x32_bf16 v[32:35], v[28:31], v[180:183], v[32:35]
    v_perm_b32 v28, v23, v23, v4
    v_perm_b32 v29, v23, v23, v5
    v_perm_b32 v30, v23, v23, v6
    v_perm_b32 v31, v23, v23, v7
    v_mfma_f32_16x16x32_bf16 v[32:35], v[24:27], v[184:187], v[32:35]
    s_nop 0
    v_mfma_f32_16x16x32_bf16 v[32:35], v[28:31], v[188:191], v[32:35]
    s_nop 7
    v_mul_f32 v32, v32, v58
    v_mul_f32 v33, v33, v58
    v_mul_f32 v34, v34, v58
    v_mul_f32 v35, v35, v58
    v_cvt_pk_bf16_f32 v16, v32, v33
    v_cvt_pk_bf16_f32 v17, v34, v35
    buffer_store_dwordx2 v[16:17], v59, s[52:55], 0 offen sc1
    v_add_u32 v46, v16, v17
    s_nop 1
    v_add_u32_dpp v46, v46, v46 quad_perm:[1,0,3,2] row_mask:0xf bank_mask:0xf
    s_nop 1
    v_add_u32_dpp v46, v46, v46 quad_perm:[2,3,0,1] row_mask:0xf bank_mask:0xf
    s_nop 1
    v_add_u32_dpp v46, v46, v46 row_half_mirror row_mask:0xf bank_mask:0xf
    v_add_u32 v47, s64, v46
    s_mov_b32 exec_lo, 0x01010101
    s_mov_b32 exec_hi, 0x01010101
    buffer_store_dwordx2 v[46:47], v60, s[52:55], 0 offen sc1
    s_mov_b64 exec, -1
    s_waitcnt vmcnt(0)
    v_mov_b32 v45, 1
    s_mov_b64 s[74:75], exec
    s_mov_b64 exec, 1
    ds_add_u32 v3, v45 offset:16
    s_mov_b64 exec, s[74:75]
    s_cmp_ge_u32 s101, 8
    s_cbranch_scc1 L_nocp_48
    buffer_store_dwordx4 v[242:245], v52, s[52:55], s3 offen sc1
    s_mov_b64 s[74:75], exec
    s_mov_b64 exec, 1
    buffer_store_dwordx2 v[246:247], v53, s[52:55], s3 offen sc1
    s_mov_b64 exec, s[74:75]
L_nocp_48:
L_Ldone:
L_exit:
    s_endpgm
L_end:
.section .rodata,"a"
.p2align 6
.amdhsa_kernel gated_mix__compressed_kv_cla__dense_activation_mish__decode_kernel
  .amdhsa_next_free_vgpr 256
  .amdhsa_next_free_sgpr 102
  .amdhsa_accum_offset 256
  .amdhsa_group_segment_fixed_size 0
  .amdhsa_kernarg_size 112
  .amdhsa_user_sgpr_count 2
  .amdhsa_user_sgpr_kernarg_segment_ptr 1
  .amdhsa_system_sgpr_workgroup_id_x 1
  .amdhsa_float_denorm_mode_32 3
.end_amdhsa_kernel
```
